```python
import torch

def _softmax(x, axis=-1):
    return torch.softmax(x, dim=axis)
def _gelu(x):
    return torch.nn.functional.gelu(x, approximate="tanh")
def _silu(x):
    return torch.nn.functional.silu(x)
def _sigmoid(x):
    return torch.sigmoid(x)
def _layernorm(x, axis=-1, eps=1e-5):
    m = x.mean(dim=axis, keepdim=True)
    v = x.var(dim=axis, keepdim=True, unbiased=False)
    return (x - m) / torch.sqrt(v + eps)
def _scatter_add(tgt, idx, src, axis=0):
    return tgt.clone().index_add_(axis, idx, src)
def _segment_sum(src, seg, n):
    out = torch.zeros((n,) + src.shape[1:], dtype=src.dtype)
    return out.index_add_(0, seg, src)
def _pad(x, pw):
    flat = tuple(v for pair in reversed(pw) for v in pair)
    return torch.nn.functional.pad(x, flat)

kernel_name = 'recurrent_scan__ssm_conv_h3__dense_activation_silu__prompt'

def setup_inputs():

    _w = (lambda a: (lambda t: t.to(torch.bfloat16) if t.is_floating_point() else t)(torch.as_tensor(a)))
    def _A_setup():
        B, S, D = 1, 2048, 640
        ks = 4
        return {
            "q": _w((lambda *s: torch.randn(*s, dtype=torch.bfloat16) * 0.05)(B, S, D)),
            "k": _w((lambda *s: torch.randn(*s, dtype=torch.bfloat16) * 0.8)(B, S, D)),
            "v": _w((lambda *s: torch.randn(*s, dtype=torch.bfloat16) * 0.8)(B, S, D)),
            "shift_k": _w((lambda *s: torch.randn(*s, dtype=torch.bfloat16) * 0.8)(D, ks) * 0.5),
            "ssm_k": _w((lambda *s: torch.randn(*s, dtype=torch.bfloat16) * 0.8)(D, S) * (1.0 / S ** 0.5)),
            "ssm_D": _w((lambda *s: torch.randn(*s, dtype=torch.bfloat16) * 0.8)(D)),
        }
    _A_in = _A_setup()

    def _B_setup():
        B, S, D, F = 1, 2048, 640, 1728
        return {
            "x": _w((lambda *s: torch.randn(*s, dtype=torch.bfloat16) * 0.05)(B, S, D)),
            "w1": _w((lambda *s: torch.randn(*s, dtype=torch.bfloat16) * 0.8)(D, F) * (D ** -0.5)),
            "w2": _w((lambda *s: torch.randn(*s, dtype=torch.bfloat16) * 0.2)(F, D) * (F ** -0.5)),
        }
    _B_in = _B_setup()

    return {
        "A_q": _A_in["q"],
        "A_k": _A_in["k"],
        "A_v": _A_in["v"],
        "A_shift_k": _A_in["shift_k"],
        "A_ssm_k": _A_in["ssm_k"],
        "A_ssm_D": _A_in["ssm_D"],
        "B_x": _B_in["x"],
        "B_w1": _B_in["w1"],
        "B_w2": _B_in["w2"],
    }

def reference(A_q, A_k, A_v, A_shift_k, A_ssm_k, A_ssm_D, B_x, B_w1, B_w2):
    def _A_ref(q, k, v, shift_k, ssm_k, ssm_D):
        B, S, D = q.shape
        ks = shift_k.shape[-1]
        k_pad = _pad(k, ((0, 0), (ks - 1, 0), (0, 0)))
        k_shift = torch.zeros_like(k)
        for t in range(ks):
            k_shift = k_shift + k_pad[:, t:t + S, :] * shift_k[:, ks - 1 - t][None, None, :]
        kv = k_shift * v
        L = 2 * S
        kv_pad = _pad(kv, ((0, 0), (0, S), (0, 0)))
        kf_pad = _pad(ssm_k, ((0, 0), (0, S)))
        kv_f = (lambda x, axes=(-2,-1): torch.fft.rfft2(x.float(), dim=axes))(kv_pad[:, None, :, :], axes=(1, 2))
        kf_f = (lambda x, axes=(-2,-1): torch.fft.rfft2(x.float(), dim=axes))(kf_pad[:, None, :], axes=(1, 2))
        kf_f = (lambda x, *d: x.permute(*d))(kf_f, 1, 2, 0)
        y_f = kv_f * kf_f[None, :, :, :]
        y = (lambda x, s, axes=(-2,-1): torch.fft.irfft2(x, s=s, dim=axes).to(torch.bfloat16))(y_f, (1, L), axes=(1, 2))[:, 0, :S, :]
        y = y + kv * ssm_D[None, None, :]
        return q * y

    def _B_ref(x, w1, w2):
        h = torch.einsum("bsd,df->bsf", x, w1)
        h = _silu(h)
        out = torch.einsum("bsf,fd->bsd", h, w2)
        return out

    x = A_q
    xn = _layernorm(x, axis=-1)
    s = _A_ref(xn, A_k, A_v, A_shift_k, A_ssm_k, A_ssm_D)
    g = _silu(_B_ref(xn, B_w1, B_w2))
    return x + s * g
```

```asm
; @launch kernel=recurrent_scan__ssm_conv_h3__dense_activation_silu__prompt_kernel grid=(256,1,1) block=(512,1,1) lds=160320
.amdgcn_target "amdgcn-amd-amdhsa--gfx950"
.text
.globl recurrent_scan__ssm_conv_h3__dense_activation_silu__prompt_kernel
.p2align 8
.type recurrent_scan__ssm_conv_h3__dense_activation_silu__prompt_kernel,@function
recurrent_scan__ssm_conv_h3__dense_activation_silu__prompt_kernel:
    s_cmp_ge_u32 s2, 256
    s_cbranch_scc1 K1_END
    s_load_dwordx4 s[36:39], s[0:1], 0
    s_load_dwordx4 s[40:43], s[0:1], 16
    s_load_dwordx4 s[44:47], s[0:1], 56
    s_load_dwordx2 s[60:61], s[0:1], 88
    s_load_dwordx4 s[68:71], s[0:1], 32
    s_load_dwordx4 s[72:75], s[0:1], 72
    v_lshrrev_b32 v1, 6, v0
    v_and_b32 v2, 63, v0
    v_readfirstlane_b32 s3, v1
    s_and_b32 s4, s2, 7
    s_lshr_b32 s5, s2, 3
    s_mul_i32 s6, s5, 37
    s_lshr_b32 s6, s6, 8
    s_mul_i32 s7, s6, 7
    s_sub_u32 s7, s5, s7
    s_lshr_b32 s32, s4, 1
    s_lshl_b32 s32, s32, 2
    s_add_u32 s6, s6, s32
    s_and_b32 s32, s4, 1
    s_mul_i32 s32, s32, 7
    s_add_u32 s7, s7, s32
    s_lshr_b32 s32, s3, 1
    s_and_b32 s33, s3, 1
    s_mov_b32 s90, 0xbfb8aa3b
    v_and_b32 v16, 15, v2
    v_lshrrev_b32 v17, 4, v2
    s_lshl_b32 s48, s3, 2
    v_add_u32 v13, s48, v17
    v_and_b32 v14, 7, v13
    v_lshlrev_b32 v14, 1, v14
    v_xor_b32 v14, v16, v14
    v_lshrrev_b32 v22, 2, v16
    v_and_b32 v23, 1, v17
    v_lshl_or_b32 v22, v23, 2, v22
    v_lshrrev_b32 v23, 1, v17
    v_lshl_or_b32 v23, v23, 4, v22
    v_lshlrev_b32 v23, 8, v23
    v_and_b32 v24, 1, v2
    v_lshl_add_u32 v23, v24, 3, v23
    v_bfe_u32 v24, v2, 1, 1
    v_lshlrev_b32 v22, 1, v22
    v_lshrrev_b32 v32, 3, v2
    v_mul_u32_u24 v32, 1280, v32
    v_and_b32 v33, 7, v2
    v_lshl_add_u32 v32, v33, 4, v32
    v_and_b32 v33, 31, v0
    v_lshrrev_b32 v34, 5, v0
    v_lshlrev_b32 v35, 9, v34
    v_lshl_add_u32 v35, v33, 2, v35
    v_mul_u32_u24 v36, 272, v33
    v_lshlrev_b32 v37, 3, v34
    v_sub_u32 v37, 17528, v37
    v_add_u32 v36, v36, v37
    v_lshlrev_b32 v33, 4, v33
    v_lshrrev_b32 v37, 3, v0
    v_and_b32 v38, 7, v0
    v_mul_u32_u24 v34, 136, v37
    v_lshl_add_u32 v34, v38, 4, v34
    v_add_u32 v34, 17408, v34
    v_lshlrev_b32 v37, 12, v37
    v_lshl_add_u32 v37, v38, 4, v37
    v_and_b32 v15, 0x13, v13
    v_and_b32 v18, 4, v13
    v_lshlrev_b32 v18, 1, v18
    v_or_b32 v15, v15, v18
    v_and_b32 v18, 8, v13
    v_lshrrev_b32 v18, 1, v18
    v_or_b32 v15, v15, v18
    s_movk_i32 s48, 3456
    v_mul_lo_u32 v15, v15, s48
    v_lshl_add_u32 v15, v14, 4, v15
    s_lshl_b32 s48, s7, 8
    v_add_u32 v15, s48, v15
    v_lshrrev_b32 v18, 3, v2
    v_and_b32 v19, 7, v2
    v_lshrrev_b32 v20, 1, v18
    v_xor_b32 v21, v19, v20
    v_xor_b32 v25, 4, v21
    s_lshl_b32 s48, s6, 7
    s_lshl_b32 s49, s3, 4
    s_add_u32 s48, s48, s49
    v_add_u32 v18, s48, v18
    s_movk_i32 s49, 1280
    v_mul_lo_u32 v18, v18, s49
    v_lshl_add_u32 v19, v25, 4, v18
    v_add_u32 v19, 10240, v19
    v_lshl_add_u32 v18, v21, 4, v18
    s_lshl_b32 s52, s3, 11
    s_lshl_b32 s53, s3, 10
    s_add_u32 s53, s53, 16384
    s_waitcnt lgkmcnt(0)
    s_mov_b32 s28, s60
    s_and_b32 s29, s61, 0xffff
    s_mov_b32 s30, 20971520
    s_mov_b32 s31, 0x00020000
    s_mov_b32 s16, s38
    s_and_b32 s17, s39, 0xffff
    s_mov_b32 s18, 2621440
    s_mov_b32 s19, 0x00020000
    s_mov_b32 s20, s40
    s_and_b32 s21, s41, 0xffff
    s_mov_b32 s22, 2621440
    s_mov_b32 s23, 0x00020000
    s_mov_b32 s24, s42
    s_and_b32 s25, s43, 0xffff
    s_mov_b32 s26, 5120
    s_mov_b32 s27, 0x00020000
    s_mov_b32 s96, s74
    s_and_b32 s97, s75, 0xffff
    s_mov_b32 s98, 256
    s_mov_b32 s99, 0x00020000
    v_mov_b32 v40, 0
    v_mov_b32 v41, 0
    v_mov_b32 v42, 0
    v_mov_b32 v43, 0
    v_mov_b32 v44, 160256
    ds_write_b128 v44, v[40:43]
    ds_write_b128 v44, v[40:43] offset:16
    s_cmp_lg_u32 s2, 224
    s_cbranch_scc1 F_NOMB
    s_cmp_lg_u32 s3, 7
    s_cbranch_scc1 F_NOMB
    v_lshlrev_b32 v45, 8, v2
    v_add_u32 v45, 16973824, v45
    buffer_store_dword v40, v45, s[28:31], 0 offen sc1
    v_lshlrev_b32 v45, 4, v2
    s_mov_b32 s48, 16990208
F_ZMB:
    buffer_store_dwordx4 v[40:43], v45, s[28:31], s48 offen sc1
    buffer_store_dwordx4 v[40:43], v45, s[28:31], s48 offen offset:1024 sc1
    buffer_store_dwordx4 v[40:43], v45, s[28:31], s48 offen offset:2048 sc1
    buffer_store_dwordx4 v[40:43], v45, s[28:31], s48 offen offset:3072 sc1
    s_nop 1
    s_add_u32 s48, s48, 4096
    s_cmp_lt_u32 s48, 17022976
    s_cbranch_scc1 F_ZMB
    v_mov_b32 v46, 1
    s_waitcnt vmcnt(0)
    s_mov_b64 exec, 1
    buffer_store_dword v46, v40, s[96:99], 0 offen sc1
    s_mov_b64 exec, -1
F_NOMB:
    s_nop 1
    s_sub_u32 s48, s3, 4
    s_mul_i32 s49, s2, 3
    s_lshl_b32 s50, s2, 1
    s_add_u32 s50, s50, 128
    s_cmp_lt_u32 s2, 128
    s_cselect_b32 s49, s49, s50
    s_cselect_b32 s50, 3, 2
    s_add_u32 s100, s49, s48
    s_cmp_lt_u32 s48, s50
    s_cselect_b32 s100, s100, -1
    s_mov_b32 s8, s36
    s_and_b32 s9, s37, 0xffff
    s_mov_b32 s10, 2621440
    s_mov_b32 s11, 0x00020000
    s_mov_b32 s12, s44
    s_and_b32 s13, s45, 0xffff
    s_mov_b32 s14, 2211840
    s_mov_b32 s15, 0x00020000
    v_lshlrev_b32 v39, 4, v0
    s_mul_i32 s48, s2, 10240
    s_mul_i32 s49, s2, 8640
    buffer_load_dwordx4 v[228:231], v39, s[8:11], s48 offen
    buffer_load_dwordx4 v[232:235], v39, s[12:15], s49 offen
    v_mov_b32 v41, 0x80000000
    v_cmp_gt_u32 vcc, 128, v0
    s_nop 1
    v_cndmask_b32 v40, v41, v39, vcc
    v_cmp_gt_u32 vcc, 28, v0
    s_nop 1
    v_cndmask_b32 v39, v41, v39, vcc
    s_add_u32 s48, s48, 8192
    s_add_u32 s49, s49, 8192
    buffer_load_dwordx4 v[236:239], v40, s[8:11], s48 offen
    buffer_load_dwordx4 v[240:243], v39, s[12:15], s49 offen
    s_cmp_ge_u32 s5, 28
    s_cbranch_scc1 K1_SPARE
    s_mul_i32 s58, s5, 0
    s_mul_i32 s48, s58, 205
    s_lshr_b32 s48, s48, 11
    s_mul_i32 s48, s48, 10
    s_sub_u32 s58, s58, s48
    s_add_u32 m0, s52, 0
    s_lshl_b32 s55, s58, 7
    buffer_load_dwordx4 v18, s[8:11], s55 offen lds
    s_add_u32 m0, s52, 1024
    s_mul_i32 s54, s58, 221184
    buffer_load_dwordx4 v19, s[8:11], s55 offen lds
    s_add_u32 m0, s53, 0
    s_add_u32 s56, s54, 110592
    buffer_load_dwordx4 v15, s[12:15], s54 offen lds
    s_add_u32 m0, s53, 8192
    s_add_u32 s58, s58, 1
    buffer_load_dwordx4 v15, s[12:15], s56 offen lds
    s_cmp_eq_u32 s58, 10
    s_cselect_b32 s58, 0, s58
    s_add_u32 m0, s52, 32768
    s_lshl_b32 s55, s58, 7
    buffer_load_dwordx4 v18, s[8:11], s55 offen lds
    s_add_u32 m0, s52, 33792
    s_mul_i32 s54, s58, 221184
    buffer_load_dwordx4 v19, s[8:11], s55 offen lds
    s_add_u32 m0, s53, 32768
    s_add_u32 s56, s54, 110592
    buffer_load_dwordx4 v15, s[12:15], s54 offen lds
    s_add_u32 m0, s53, 40960
    s_add_u32 s58, s58, 1
    buffer_load_dwordx4 v15, s[12:15], s56 offen lds
    s_cmp_eq_u32 s58, 10
    s_cselect_b32 s58, 0, s58
    s_mul_i32 s57, s4, 28
    s_add_u32 s57, s57, s5
    s_lshl_b32 s48, s32, 12
    s_lshl_b32 s49, s33, 11
    s_add_u32 s48, s48, s49
    v_lshlrev_b32 v25, 7, v16
    v_add_u32 v25, s48, v25
    v_lshrrev_b32 v26, 1, v16
    v_xor_b32 v27, v17, v26
    s_and_b32 s49, s32, 1
    s_lshl_b32 s50, s49, 2
    v_xor_b32 v27, s50, v27
    v_lshl_add_u32 v180, v27, 4, v25
    v_xor_b32 v27, 4, v27
    v_lshl_add_u32 v181, v27, 4, v25
    v_add_u32 v182, 0x10000, v180
    v_add_u32 v183, 0x10000, v181
    s_lshl_b32 s48, s33, 3
    s_and_b32 s50, s32, 2
    s_lshl_b32 s50, s50, 1
    s_lshl_b32 s49, s49, 13
    v_add_u32 v26, s49, v23
    s_xor_b32 s51, s50, 0
    s_add_u32 s51, s51, s48
    v_add_u32 v25, s51, v24
    v_xor_b32 v25, v25, v22
    v_lshl_add_u32 v184, v25, 4, v26
    v_add_u32 v188, 0x10000, v184
    s_xor_b32 s51, s50, 2
    s_add_u32 s51, s51, s48
    v_add_u32 v25, s51, v24
    v_xor_b32 v25, v25, v22
    v_lshl_add_u32 v185, v25, 4, v26
    v_add_u32 v189, 0x10000, v185
    s_xor_b32 s51, s50, 4
    s_add_u32 s51, s51, s48
    v_add_u32 v25, s51, v24
    v_xor_b32 v25, v25, v22
    v_lshl_add_u32 v186, v25, 4, v26
    v_add_u32 v190, 0x10000, v186
    s_xor_b32 s51, s50, 6
    s_add_u32 s51, s51, s48
    v_add_u32 v25, s51, v24
    v_xor_b32 v25, v25, v22
    v_lshl_add_u32 v187, v25, 4, v26
    v_add_u32 v191, 0x10000, v187
    v_xor_b32 v192, 0x800, v180
    v_xor_b32 v193, 0x800, v181
    v_xor_b32 v194, 0x800, v182
    v_xor_b32 v195, 0x800, v183
    v_xor_b32 v196, 0x2000, v184
    v_xor_b32 v197, 0x2000, v185
    v_xor_b32 v198, 0x2000, v186
    v_xor_b32 v199, 0x2000, v187
    v_xor_b32 v200, 0x2000, v188
    v_xor_b32 v201, 0x2000, v189
    v_xor_b32 v202, 0x2000, v190
    v_xor_b32 v203, 0x2000, v191
    v_mov_b32 v136, 0
    v_mov_b32 v137, 0
    v_mov_b32 v138, 0
    v_mov_b32 v139, 0
    v_mov_b32 v140, 0
    v_mov_b32 v141, 0
    v_mov_b32 v142, 0
    v_mov_b32 v143, 0
    v_mov_b32 v144, 0
    v_mov_b32 v145, 0
    v_mov_b32 v146, 0
    v_mov_b32 v147, 0
    v_mov_b32 v148, 0
    v_mov_b32 v149, 0
    v_mov_b32 v150, 0
    v_mov_b32 v151, 0
    v_mov_b32 v152, 0
    v_mov_b32 v153, 0
    v_mov_b32 v154, 0
    v_mov_b32 v155, 0
    v_mov_b32 v156, 0
    v_mov_b32 v157, 0
    v_mov_b32 v158, 0
    v_mov_b32 v159, 0
    v_mov_b32 v160, 0
    v_mov_b32 v161, 0
    v_mov_b32 v162, 0
    v_mov_b32 v163, 0
    v_mov_b32 v164, 0
    v_mov_b32 v165, 0
    v_mov_b32 v166, 0
    v_mov_b32 v167, 0
    v_mov_b32 v168, 0
    v_mov_b32 v169, 0
    v_mov_b32 v170, 0
    v_mov_b32 v171, 0
    v_mov_b32 v172, 0
    v_mov_b32 v173, 0
    v_mov_b32 v174, 0
    v_mov_b32 v175, 0
    v_mov_b32 v176, 0
    v_mov_b32 v177, 0
    v_mov_b32 v178, 0
    v_mov_b32 v179, 0
    v_mov_b32 v204, 0
    v_mov_b32 v205, 0
    v_mov_b32 v206, 0
    v_mov_b32 v207, 0
    v_mov_b32 v28, 0x3f803f80
    v_mov_b32 v29, 0x3f803f80
    v_mov_b32 v30, 0x3f803f80
    v_mov_b32 v31, 0x3f803f80
    v_add_u32 v9, 133760, v35
    v_add_u32 v10, 142336, v35
    v_add_u32 v11, 133120, v36
    v_add_u32 v12, 133120, v34
    s_waitcnt vmcnt(4)
    s_barrier
    ds_read_b128 v[40:43], v180 offset:0
    ds_read_b128 v[44:47], v192 offset:0
    ds_read_b64_tr_b16 v[56:57], v184 offset:16384
    ds_read_b64_tr_b16 v[58:59], v184 offset:18432
    ds_read_b64_tr_b16 v[60:61], v185 offset:16384
    ds_read_b64_tr_b16 v[62:63], v185 offset:18432
    ds_read_b64_tr_b16 v[64:65], v186 offset:16384
    ds_read_b64_tr_b16 v[66:67], v186 offset:18432
    ds_read_b64_tr_b16 v[68:69], v187 offset:16384
    ds_read_b64_tr_b16 v[70:71], v187 offset:18432
    ds_read_b128 v[48:51], v181 offset:0
    ds_read_b128 v[52:55], v193 offset:0
    ds_read_b64_tr_b16 v[72:73], v196 offset:16384
    ds_read_b64_tr_b16 v[74:75], v196 offset:18432
    ds_read_b64_tr_b16 v[76:77], v197 offset:16384
    ds_read_b64_tr_b16 v[78:79], v197 offset:18432
    ds_read_b64_tr_b16 v[80:81], v198 offset:16384
    ds_read_b64_tr_b16 v[82:83], v198 offset:18432
    ds_read_b64_tr_b16 v[84:85], v199 offset:16384
    ds_read_b64_tr_b16 v[86:87], v199 offset:18432
    s_waitcnt vmcnt(0) lgkmcnt(0)
    s_barrier
    v_mfma_f32_16x16x32_bf16 v[136:139], v[56:59], v[40:43], v[136:139]
    ds_read_b128 v[88:91], v180 offset:32768
    ds_read_b128 v[92:95], v192 offset:32768
    v_mfma_f32_16x16x32_bf16 v[152:155], v[56:59], v[44:47], v[152:155]
    s_add_u32 m0, s52, 65536
    s_lshl_b32 s55, s58, 7
    buffer_load_dwordx4 v18, s[8:11], s55 offen lds
    v_mfma_f32_16x16x32_bf16 v[168:171], v[56:59], v[28:31], v[168:171]
    ds_read_b64_tr_b16 v[104:105], v184 offset:49152
    v_mfma_f32_16x16x32_bf16 v[140:143], v[60:63], v[40:43], v[140:143]
    ds_read_b64_tr_b16 v[106:107], v184 offset:51200
    s_add_u32 m0, s52, 66560
    s_mul_i32 s54, s58, 221184
    buffer_load_dwordx4 v19, s[8:11], s55 offen lds
    v_mfma_f32_16x16x32_bf16 v[156:159], v[60:63], v[44:47], v[156:159]
    ds_read_b64_tr_b16 v[108:109], v185 offset:49152
    v_mfma_f32_16x16x32_bf16 v[172:175], v[60:63], v[28:31], v[172:175]
    ds_read_b64_tr_b16 v[110:111], v185 offset:51200
    v_mfma_f32_16x16x32_bf16 v[144:147], v[64:67], v[40:43], v[144:147]
    s_add_u32 m0, s53, 65536
    s_add_u32 s56, s54, 110592
    buffer_load_dwordx4 v15, s[12:15], s54 offen lds
    ds_read_b64_tr_b16 v[112:113], v186 offset:49152
    v_mfma_f32_16x16x32_bf16 v[160:163], v[64:67], v[44:47], v[160:163]
    ds_read_b64_tr_b16 v[114:115], v186 offset:51200
    v_mfma_f32_16x16x32_bf16 v[176:179], v[28:31], v[40:43], v[176:179]
    s_add_u32 m0, s53, 73728
    s_add_u32 s58, s58, 1
    buffer_load_dwordx4 v15, s[12:15], s56 offen lds
    s_cmp_eq_u32 s58, 10
    s_cselect_b32 s58, 0, s58
    v_mfma_f32_16x16x32_bf16 v[148:151], v[68:71], v[40:43], v[148:151]
    ds_read_b64_tr_b16 v[116:117], v187 offset:49152
    ds_read_b64_tr_b16 v[118:119], v187 offset:51200
    v_mfma_f32_16x16x32_bf16 v[164:167], v[68:71], v[44:47], v[164:167]
    ds_read_b128 v[96:99], v181 offset:32768
    v_mfma_f32_16x16x32_bf16 v[204:207], v[40:43], v[40:43], v[204:207]
    ds_read_b128 v[100:103], v193 offset:32768
    v_mfma_f32_16x16x32_bf16 v[136:139], v[72:75], v[48:51], v[136:139]
    s_mul_i32 s48, s57, 205
    s_lshr_b32 s48, s48, 11
    s_mul_i32 s49, s48, 10
    s_sub_u32 s49, s57, s49
    s_lshl_b32 s50, s49, 18
    s_lshl_b32 s51, s48, 7
    s_sub_u32 s34, 7344000, s51
    s_add_u32 s34, s34, s50
    s_mul_i32 s50, s48, 81920
    s_lshl_b32 s51, s49, 7
    s_add_u32 s50, s50, s51
    s_mul_i32 s51, s3, 10240
    s_add_u32 s51, s51, s50
    s_lshl_b32 s62, s3, 10
    s_add_u32 m0, s62, 134144
    s_sub_u32 s63, s50, 10240
    buffer_load_dwordx4 v32, s[16:19], s51 offen lds
    s_add_u32 m0, s62, 142336
    s_cmp_eq_u32 s48, 0
    buffer_load_dwordx4 v32, s[20:23], s51 offen lds
    s_cselect_b32 s63, 0x40000000, s63
    s_mov_b32 m0, 133120
    s_lshl_b32 s49, s49, 9
    buffer_load_dwordx4 v32, s[16:19], s63 offen lds
    buffer_load_dwordx4 v[220:223], v33, s[24:27], s49 offen
    v_mov_b32 v248, 0
    buffer_load_dword v249, v248, s[96:99], 0 offen sc1
    ds_read_b64_tr_b16 v[120:121], v196 offset:49152
    v_mfma_f32_16x16x32_bf16 v[152:155], v[72:75], v[52:55], v[152:155]
    ds_read_b64_tr_b16 v[122:123], v196 offset:51200
    v_mfma_f32_16x16x32_bf16 v[140:143], v[76:79], v[48:51], v[140:143]
    ds_read_b64_tr_b16 v[124:125], v197 offset:49152
    v_mfma_f32_16x16x32_bf16 v[156:159], v[76:79], v[52:55], v[156:159]
    ds_read_b64_tr_b16 v[126:127], v197 offset:51200
    ds_read_b64_tr_b16 v[128:129], v198 offset:49152
    v_mfma_f32_16x16x32_bf16 v[144:147], v[80:83], v[48:51], v[144:147]
    s_add_u32 m0, s52, 98304
    s_lshl_b32 s55, s58, 7
    buffer_load_dwordx4 v18, s[8:11], s55 offen lds
    v_mfma_f32_16x16x32_bf16 v[160:163], v[80:83], v[52:55], v[160:163]
    ds_read_b64_tr_b16 v[130:131], v198 offset:51200
    v_mfma_f32_16x16x32_bf16 v[176:179], v[28:31], v[48:51], v[176:179]
    ds_read_b64_tr_b16 v[132:133], v199 offset:49152
    ds_read_b64_tr_b16 v[134:135], v199 offset:51200
    v_mfma_f32_16x16x32_bf16 v[148:151], v[84:87], v[48:51], v[148:151]
    s_add_u32 m0, s52, 99328
    s_mul_i32 s54, s58, 221184
    buffer_load_dwordx4 v19, s[8:11], s55 offen lds
    v_mfma_f32_16x16x32_bf16 v[164:167], v[84:87], v[52:55], v[164:167]
    s_add_u32 m0, s53, 98304
    s_add_u32 s56, s54, 110592
    buffer_load_dwordx4 v15, s[12:15], s54 offen lds
    v_mfma_f32_16x16x32_bf16 v[204:207], v[48:51], v[48:51], v[204:207]
    s_add_u32 m0, s53, 106496
    s_add_u32 s58, s58, 1
    buffer_load_dwordx4 v15, s[12:15], s56 offen lds
    s_cmp_eq_u32 s58, 10
    s_cselect_b32 s58, 0, s58
    s_waitcnt vmcnt(9) lgkmcnt(0)
    s_barrier
    v_mfma_f32_16x16x32_bf16 v[136:139], v[104:107], v[88:91], v[136:139]
    ds_read_b128 v[40:43], v182 offset:0
    ds_read_b128 v[44:47], v194 offset:0
    v_mfma_f32_16x16x32_bf16 v[152:155], v[104:107], v[92:95], v[152:155]
    s_add_u32 m0, s52, 0
    s_lshl_b32 s55, s58, 7
    buffer_load_dwordx4 v18, s[8:11], s55 offen lds
    v_mfma_f32_16x16x32_bf16 v[168:171], v[104:107], v[28:31], v[168:171]
    ds_read_b64_tr_b16 v[56:57], v188 offset:16384
    v_mfma_f32_16x16x32_bf16 v[140:143], v[108:111], v[88:91], v[140:143]
    ds_read_b64_tr_b16 v[58:59], v188 offset:18432
    s_add_u32 m0, s52, 1024
    s_mul_i32 s54, s58, 221184
    buffer_load_dwordx4 v19, s[8:11], s55 offen lds
    v_mfma_f32_16x16x32_bf16 v[156:159], v[108:111], v[92:95], v[156:159]
    ds_read_b64_tr_b16 v[60:61], v189 offset:16384
    v_mfma_f32_16x16x32_bf16 v[172:175], v[108:111], v[28:31], v[172:175]
    ds_read_b64_tr_b16 v[62:63], v189 offset:18432
    v_mfma_f32_16x16x32_bf16 v[144:147], v[112:115], v[88:91], v[144:147]
    s_add_u32 m0, s53, 0
    s_add_u32 s56, s54, 110592
    buffer_load_dwordx4 v15, s[12:15], s54 offen lds
    v_mfma_f32_16x16x32_bf16 v[160:163], v[112:115], v[92:95], v[160:163]
    ds_read_b64_tr_b16 v[64:65], v190 offset:16384
    s_add_u32 m0, s53, 8192
    s_add_u32 s58, s58, 1
    buffer_load_dwordx4 v15, s[12:15], s56 offen lds
    s_cmp_eq_u32 s58, 10
    s_cselect_b32 s58, 0, s58
    v_mfma_f32_16x16x32_bf16 v[176:179], v[28:31], v[88:91], v[176:179]
    ds_read_b64_tr_b16 v[66:67], v190 offset:18432
    v_mfma_f32_16x16x32_bf16 v[148:151], v[116:119], v[88:91], v[148:151]
    ds_read_b64_tr_b16 v[68:69], v191 offset:16384
    v_mfma_f32_16x16x32_bf16 v[164:167], v[116:119], v[92:95], v[164:167]
    ds_read_b64_tr_b16 v[70:71], v191 offset:18432
    v_mfma_f32_16x16x32_bf16 v[204:207], v[88:91], v[88:91], v[204:207]
    ds_read_b128 v[48:51], v183 offset:0
    ds_read_b128 v[52:55], v195 offset:0
    v_mfma_f32_16x16x32_bf16 v[136:139], v[120:123], v[96:99], v[136:139]
    s_add_u32 m0, s52, 32768
    s_lshl_b32 s55, s58, 7
    buffer_load_dwordx4 v18, s[8:11], s55 offen lds
    v_mfma_f32_16x16x32_bf16 v[152:155], v[120:123], v[100:103], v[152:155]
    ds_read_b64_tr_b16 v[72:73], v200 offset:16384
    v_mfma_f32_16x16x32_bf16 v[140:143], v[124:127], v[96:99], v[140:143]
    ds_read_b64_tr_b16 v[74:75], v200 offset:18432
    ds_read_b64_tr_b16 v[76:77], v201 offset:16384
    v_mfma_f32_16x16x32_bf16 v[156:159], v[124:127], v[100:103], v[156:159]
    ds_read_b64_tr_b16 v[78:79], v201 offset:18432
    v_mfma_f32_16x16x32_bf16 v[144:147], v[128:131], v[96:99], v[144:147]
    ds_read_b64_tr_b16 v[80:81], v202 offset:16384
    v_mfma_f32_16x16x32_bf16 v[160:163], v[128:131], v[100:103], v[160:163]
    s_add_u32 m0, s52, 33792
    s_mul_i32 s54, s58, 221184
    buffer_load_dwordx4 v19, s[8:11], s55 offen lds
    v_mfma_f32_16x16x32_bf16 v[176:179], v[28:31], v[96:99], v[176:179]
    ds_read_b64_tr_b16 v[82:83], v202 offset:18432
    ds_read_b64_tr_b16 v[84:85], v203 offset:16384
    v_mfma_f32_16x16x32_bf16 v[148:151], v[132:135], v[96:99], v[148:151]
    ds_read_b64_tr_b16 v[86:87], v203 offset:18432
    v_mfma_f32_16x16x32_bf16 v[164:167], v[132:135], v[100:103], v[164:167]
    s_add_u32 m0, s53, 32768
    s_add_u32 s56, s54, 110592
    buffer_load_dwordx4 v15, s[12:15], s54 offen lds
    v_mfma_f32_16x16x32_bf16 v[204:207], v[96:99], v[96:99], v[204:207]
    s_add_u32 m0, s53, 40960
    s_add_u32 s58, s58, 1
    buffer_load_dwordx4 v15, s[12:15], s56 offen lds
    s_cmp_eq_u32 s58, 10
    s_cselect_b32 s58, 0, s58
    s_waitcnt vmcnt(8) lgkmcnt(0)
    s_barrier
    v_mfma_f32_16x16x32_bf16 v[136:139], v[56:59], v[40:43], v[136:139]
    ds_read_b128 v[88:91], v182 offset:32768
    ds_read_b128 v[92:95], v194 offset:32768
    v_mfma_f32_16x16x32_bf16 v[152:155], v[56:59], v[44:47], v[152:155]
    s_add_u32 m0, s52, 65536
    s_lshl_b32 s55, s58, 7
    buffer_load_dwordx4 v18, s[8:11], s55 offen lds
    v_mfma_f32_16x16x32_bf16 v[168:171], v[56:59], v[28:31], v[168:171]
    ds_read_b64_tr_b16 v[104:105], v188 offset:49152
    ds_read_b64_tr_b16 v[106:107], v188 offset:51200
    v_mfma_f32_16x16x32_bf16 v[140:143], v[60:63], v[40:43], v[140:143]
    ds_read_b64_tr_b16 v[108:109], v189 offset:49152
    v_mfma_f32_16x16x32_bf16 v[156:159], v[60:63], v[44:47], v[156:159]
    ds_read_b64_tr_b16 v[110:111], v189 offset:51200
    v_mfma_f32_16x16x32_bf16 v[172:175], v[60:63], v[28:31], v[172:175]
    ds_read_b64_tr_b16 v[112:113], v190 offset:49152
    s_add_u32 m0, s52, 66560
    s_mul_i32 s54, s58, 221184
    buffer_load_dwordx4 v19, s[8:11], s55 offen lds
    v_mfma_f32_16x16x32_bf16 v[144:147], v[64:67], v[40:43], v[144:147]
    ds_read_b64_tr_b16 v[114:115], v190 offset:51200
    v_mfma_f32_16x16x32_bf16 v[160:163], v[64:67], v[44:47], v[160:163]
    ds_read_b64_tr_b16 v[116:117], v191 offset:49152
    v_mfma_f32_16x16x32_bf16 v[176:179], v[28:31], v[40:43], v[176:179]
    ds_read_b64_tr_b16 v[118:119], v191 offset:51200
    ds_read_b128 v[96:99], v183 offset:32768
    v_mfma_f32_16x16x32_bf16 v[148:151], v[68:71], v[40:43], v[148:151]
    ds_read_b128 v[100:103], v195 offset:32768
    v_mfma_f32_16x16x32_bf16 v[164:167], v[68:71], v[44:47], v[164:167]
    s_add_u32 m0, s53, 65536
    s_add_u32 s56, s54, 110592
    buffer_load_dwordx4 v15, s[12:15], s54 offen lds
    v_mfma_f32_16x16x32_bf16 v[204:207], v[40:43], v[40:43], v[204:207]
    ds_read_b64_tr_b16 v[120:121], v200 offset:49152
    ds_read_b64_tr_b16 v[122:123], v200 offset:51200
    v_mfma_f32_16x16x32_bf16 v[136:139], v[72:75], v[48:51], v[136:139]
    ds_read_b64_tr_b16 v[124:125], v201 offset:49152
    v_mfma_f32_16x16x32_bf16 v[152:155], v[72:75], v[52:55], v[152:155]
    ds_read_b64_tr_b16 v[126:127], v201 offset:51200
    ds_read_b64_tr_b16 v[128:129], v202 offset:49152
    v_mfma_f32_16x16x32_bf16 v[140:143], v[76:79], v[48:51], v[140:143]
    s_add_u32 m0, s53, 73728
    s_add_u32 s58, s58, 1
    buffer_load_dwordx4 v15, s[12:15], s56 offen lds
    s_cmp_eq_u32 s58, 10
    s_cselect_b32 s58, 0, s58
    v_mfma_f32_16x16x32_bf16 v[156:159], v[76:79], v[52:55], v[156:159]
    ds_read_b64_tr_b16 v[130:131], v202 offset:51200
    v_mfma_f32_16x16x32_bf16 v[144:147], v[80:83], v[48:51], v[144:147]
    ds_read_b64_tr_b16 v[132:133], v203 offset:49152
    ds_read_b64_tr_b16 v[134:135], v203 offset:51200
    v_mfma_f32_16x16x32_bf16 v[160:163], v[80:83], v[52:55], v[160:163]
    ds_read2_b32 v[208:209], v9 offset0:0 offset1:32
    v_mfma_f32_16x16x32_bf16 v[176:179], v[28:31], v[48:51], v[176:179]
    ds_read2_b32 v[210:211], v9 offset0:64 offset1:96
    v_mfma_f32_16x16x32_bf16 v[148:151], v[84:87], v[48:51], v[148:151]
    ds_read2_b32 v[212:213], v9 offset0:128 offset1:160
    ds_read2_b32 v[214:215], v9 offset0:192 offset1:224
    v_mfma_f32_16x16x32_bf16 v[164:167], v[84:87], v[52:55], v[164:167]
    ds_read2_b32 v[216:217], v10 offset0:0 offset1:32
    v_mfma_f32_16x16x32_bf16 v[204:207], v[48:51], v[48:51], v[204:207]
    ds_read2_b32 v[218:219], v10 offset0:64 offset1:96
    s_waitcnt vmcnt(8) lgkmcnt(0)
    s_barrier
    v_mfma_f32_16x16x32_bf16 v[136:139], v[104:107], v[88:91], v[136:139]
    ds_read_b128 v[40:43], v180 offset:0
    v_lshlrev_b32 v224, 16, v208
    v_lshlrev_b32 v225, 16, v209
    v_lshlrev_b32 v226, 16, v210
    v_lshlrev_b32 v227, 16, v211
    ds_read_b128 v[44:47], v192 offset:0
    v_mfma_f32_16x16x32_bf16 v[152:155], v[104:107], v[92:95], v[152:155]
    v_lshlrev_b32 v228, 16, v212
    v_lshlrev_b32 v229, 16, v213
    v_lshlrev_b32 v230, 16, v214
    v_lshlrev_b32 v231, 16, v220
    v_and_b32 v232, 0xffff0000, v220
    v_mfma_f32_16x16x32_bf16 v[168:171], v[104:107], v[28:31], v[168:171]
    s_add_u32 m0, s52, 98304
    s_lshl_b32 s55, s58, 7
    buffer_load_dwordx4 v18, s[8:11], s55 offen lds
    ds_read_b64_tr_b16 v[56:57], v184 offset:16384
    v_lshlrev_b32 v233, 16, v221
    v_and_b32 v234, 0xffff0000, v221
    v_mul_f32 v236, v224, v234
    v_mfma_f32_16x16x32_bf16 v[140:143], v[108:111], v[88:91], v[140:143]
    v_mul_f32 v237, v225, v234
    ds_read_b64_tr_b16 v[58:59], v184 offset:18432
    v_mul_f32 v238, v226, v234
    v_mul_f32 v239, v227, v234
    v_cvt_pk_bf16_f32 v244, v236, v237
    v_lshlrev_b32 v236, 16, v244
    v_mfma_f32_16x16x32_bf16 v[156:159], v[108:111], v[92:95], v[156:159]
    v_and_b32 v237, 0xffff0000, v244
    ds_read_b64_tr_b16 v[60:61], v185 offset:16384
    v_cvt_pk_bf16_f32 v245, v238, v239
    v_lshlrev_b32 v238, 16, v245
    v_and_b32 v239, 0xffff0000, v245
    v_mfma_f32_16x16x32_bf16 v[172:175], v[108:111], v[28:31], v[172:175]
    v_mul_f32 v240, v225, v233
    v_mul_f32 v241, v226, v233
    ds_read_b64_tr_b16 v[62:63], v185 offset:18432
    v_mul_f32 v242, v227, v233
    v_mul_f32 v243, v228, v233
    v_mfma_f32_16x16x32_bf16 v[144:147], v[112:115], v[88:91], v[144:147]
    v_cvt_pk_bf16_f32 v244, v240, v241
    v_lshlrev_b32 v240, 16, v244
    ds_read_b64_tr_b16 v[64:65], v186 offset:16384
    v_and_b32 v241, 0xffff0000, v244
    v_cvt_pk_bf16_f32 v245, v242, v243
    v_mfma_f32_16x16x32_bf16 v[160:163], v[112:115], v[92:95], v[160:163]
    v_lshlrev_b32 v242, 16, v245
    v_and_b32 v243, 0xffff0000, v245
    v_add_f32 v236, v236, v240
    s_add_u32 m0, s52, 99328
    s_mul_i32 s54, s58, 221184
    buffer_load_dwordx4 v19, s[8:11], s55 offen lds
    ds_read_b64_tr_b16 v[66:67], v186 offset:18432
    v_add_f32 v237, v237, v241
    v_mfma_f32_16x16x32_bf16 v[176:179], v[28:31], v[88:91], v[176:179]
    v_add_f32 v238, v238, v242
    v_add_f32 v239, v239, v243
    v_cvt_pk_bf16_f32 v244, v236, v237
    ds_read_b64_tr_b16 v[68:69], v187 offset:16384
    v_lshlrev_b32 v236, 16, v244
    v_mfma_f32_16x16x32_bf16 v[148:151], v[116:119], v[88:91], v[148:151]
    v_and_b32 v237, 0xffff0000, v244
    v_cvt_pk_bf16_f32 v245, v238, v239
    v_lshlrev_b32 v238, 16, v245
    v_and_b32 v239, 0xffff0000, v245
    ds_read_b64_tr_b16 v[70:71], v187 offset:18432
    v_mfma_f32_16x16x32_bf16 v[164:167], v[116:119], v[92:95], v[164:167]
    v_mul_f32 v240, v226, v232
    v_mul_f32 v241, v227, v232
    v_mul_f32 v242, v228, v232
    v_mul_f32 v243, v229, v232
    v_cvt_pk_bf16_f32 v244, v240, v241
    v_mfma_f32_16x16x32_bf16 v[204:207], v[88:91], v[88:91], v[204:207]
    ds_read_b128 v[48:51], v181 offset:0
    v_lshlrev_b32 v240, 16, v244
    v_and_b32 v241, 0xffff0000, v244
    v_cvt_pk_bf16_f32 v245, v242, v243
    v_lshlrev_b32 v242, 16, v245
    ds_read_b128 v[52:55], v193 offset:0
    v_mfma_f32_16x16x32_bf16 v[136:139], v[120:123], v[96:99], v[136:139]
    v_and_b32 v243, 0xffff0000, v245
    v_add_f32 v236, v236, v240
    v_add_f32 v237, v237, v241
    v_add_f32 v238, v238, v242
    v_add_f32 v239, v239, v243
    v_mfma_f32_16x16x32_bf16 v[152:155], v[120:123], v[100:103], v[152:155]
    s_add_u32 m0, s53, 98304
    s_add_u32 s56, s54, 110592
    buffer_load_dwordx4 v15, s[12:15], s54 offen lds
    ds_read_b64_tr_b16 v[72:73], v196 offset:16384
    v_cvt_pk_bf16_f32 v244, v236, v237
    v_lshlrev_b32 v236, 16, v244
    v_and_b32 v237, 0xffff0000, v244
    v_mfma_f32_16x16x32_bf16 v[140:143], v[124:127], v[96:99], v[140:143]
    v_cvt_pk_bf16_f32 v245, v238, v239
    ds_read_b64_tr_b16 v[74:75], v196 offset:18432
    v_lshlrev_b32 v238, 16, v245
    v_and_b32 v239, 0xffff0000, v245
    v_mul_f32 v240, v227, v231
    v_mul_f32 v241, v228, v231
    v_mfma_f32_16x16x32_bf16 v[156:159], v[124:127], v[100:103], v[156:159]
    v_mul_f32 v242, v229, v231
    ds_read_b64_tr_b16 v[76:77], v197 offset:16384
    v_mul_f32 v243, v230, v231
    v_cvt_pk_bf16_f32 v244, v240, v241
    v_lshlrev_b32 v240, 16, v244
    v_mfma_f32_16x16x32_bf16 v[144:147], v[128:131], v[96:99], v[144:147]
    v_and_b32 v241, 0xffff0000, v244
    v_cvt_pk_bf16_f32 v245, v242, v243
    ds_read_b64_tr_b16 v[78:79], v197 offset:18432
    v_lshlrev_b32 v242, 16, v245
    v_and_b32 v243, 0xffff0000, v245
    v_mfma_f32_16x16x32_bf16 v[160:163], v[128:131], v[100:103], v[160:163]
    v_add_f32 v236, v236, v240
    v_add_f32 v237, v237, v241
    ds_read_b64_tr_b16 v[80:81], v198 offset:16384
    v_add_f32 v238, v238, v242
    v_add_f32 v239, v239, v243
    v_mfma_f32_16x16x32_bf16 v[176:179], v[28:31], v[96:99], v[176:179]
    v_cvt_pk_bf16_f32 v244, v236, v237
    v_lshlrev_b32 v236, 16, v244
    v_and_b32 v237, 0xffff0000, v244
    s_add_u32 m0, s53, 106496
    s_add_u32 s58, s58, 1
    buffer_load_dwordx4 v15, s[12:15], s56 offen lds
    s_cmp_eq_u32 s58, 10
    s_cselect_b32 s58, 0, s58
    ds_read_b64_tr_b16 v[82:83], v198 offset:18432
    v_cvt_pk_bf16_f32 v245, v238, v239
    v_mfma_f32_16x16x32_bf16 v[148:151], v[132:135], v[96:99], v[148:151]
    v_lshlrev_b32 v238, 16, v245
    v_and_b32 v239, 0xffff0000, v245
    v_lshlrev_b32 v240, 16, v216
    ds_read_b64_tr_b16 v[84:85], v199 offset:16384
    v_lshlrev_b32 v241, 16, v217
    v_mfma_f32_16x16x32_bf16 v[164:167], v[132:135], v[100:103], v[164:167]
    v_lshlrev_b32 v242, 16, v218
    v_lshlrev_b32 v243, 16, v219
    v_mul_f32 v236, v236, v240
    v_mul_f32 v237, v237, v241
    ds_read_b64_tr_b16 v[86:87], v199 offset:18432
    v_mfma_f32_16x16x32_bf16 v[204:207], v[96:99], v[96:99], v[204:207]
    v_mul_f32 v238, v238, v242
    v_mul_f32 v239, v239, v243
    v_cvt_pk_bf16_f32 v246, v239, v238
    v_cvt_pk_bf16_f32 v247, v237, v236
    ds_write_b64 v11, v[246:247] offset:0
    s_waitcnt vmcnt(8) lgkmcnt(0)
    s_barrier
    v_mfma_f32_16x16x32_bf16 v[136:139], v[56:59], v[40:43], v[136:139]
    ds_read_b128 v[88:91], v180 offset:32768
    v_and_b32 v224, 0xffff0000, v208
    v_and_b32 v225, 0xffff0000, v209
    v_and_b32 v226, 0xffff0000, v210
    v_and_b32 v227, 0xffff0000, v211
    ds_read_b128 v[92:95], v192 offset:32768
    v_mfma_f32_16x16x32_bf16 v[152:155], v[56:59], v[44:47], v[152:155]
    v_and_b32 v228, 0xffff0000, v212
    v_and_b32 v229, 0xffff0000, v213
    v_and_b32 v230, 0xffff0000, v214
    v_lshlrev_b32 v231, 16, v222
    v_and_b32 v232, 0xffff0000, v222
    v_mfma_f32_16x16x32_bf16 v[168:171], v[56:59], v[28:31], v[168:171]
    s_add_u32 m0, s52, 0
    s_lshl_b32 s55, s58, 7
    buffer_load_dwordx4 v18, s[8:11], s55 offen lds
    ds_read_b64_tr_b16 v[104:105], v184 offset:49152
    v_lshlrev_b32 v233, 16, v223
    v_and_b32 v234, 0xffff0000, v223
    v_mul_f32 v236, v224, v234
    v_mfma_f32_16x16x32_bf16 v[140:143], v[60:63], v[40:43], v[140:143]
    v_mul_f32 v237, v225, v234
    ds_read_b64_tr_b16 v[106:107], v184 offset:51200
    v_mul_f32 v238, v226, v234
    v_mul_f32 v239, v227, v234
    v_cvt_pk_bf16_f32 v244, v236, v237
    v_lshlrev_b32 v236, 16, v244
    v_mfma_f32_16x16x32_bf16 v[156:159], v[60:63], v[44:47], v[156:159]
    v_and_b32 v237, 0xffff0000, v244
    ds_read_b64_tr_b16 v[108:109], v185 offset:49152
    v_cvt_pk_bf16_f32 v245, v238, v239
    v_lshlrev_b32 v238, 16, v245
    v_and_b32 v239, 0xffff0000, v245
    v_mfma_f32_16x16x32_bf16 v[172:175], v[60:63], v[28:31], v[172:175]
    v_mul_f32 v240, v225, v233
    v_mul_f32 v241, v226, v233
    ds_read_b64_tr_b16 v[110:111], v185 offset:51200
    v_mul_f32 v242, v227, v233
    v_mul_f32 v243, v228, v233
    v_mfma_f32_16x16x32_bf16 v[144:147], v[64:67], v[40:43], v[144:147]
    v_cvt_pk_bf16_f32 v244, v240, v241
    v_lshlrev_b32 v240, 16, v244
    ds_read_b64_tr_b16 v[112:113], v186 offset:49152
    v_and_b32 v241, 0xffff0000, v244
    v_cvt_pk_bf16_f32 v245, v242, v243
    v_mfma_f32_16x16x32_bf16 v[160:163], v[64:67], v[44:47], v[160:163]
    v_lshlrev_b32 v242, 16, v245
    v_and_b32 v243, 0xffff0000, v245
    v_add_f32 v236, v236, v240
    s_add_u32 m0, s52, 1024
    s_mul_i32 s54, s58, 221184
    buffer_load_dwordx4 v19, s[8:11], s55 offen lds
    ds_read_b64_tr_b16 v[114:115], v186 offset:51200
    v_add_f32 v237, v237, v241
    v_mfma_f32_16x16x32_bf16 v[176:179], v[28:31], v[40:43], v[176:179]
    v_add_f32 v238, v238, v242
    v_add_f32 v239, v239, v243
    v_cvt_pk_bf16_f32 v244, v236, v237
    ds_read_b64_tr_b16 v[116:117], v187 offset:49152
    v_lshlrev_b32 v236, 16, v244
    v_mfma_f32_16x16x32_bf16 v[148:151], v[68:71], v[40:43], v[148:151]
    v_and_b32 v237, 0xffff0000, v244
    v_cvt_pk_bf16_f32 v245, v238, v239
    v_lshlrev_b32 v238, 16, v245
    v_and_b32 v239, 0xffff0000, v245
    ds_read_b64_tr_b16 v[118:119], v187 offset:51200
    v_mfma_f32_16x16x32_bf16 v[164:167], v[68:71], v[44:47], v[164:167]
    v_mul_f32 v240, v226, v232
    v_mul_f32 v241, v227, v232
    v_mul_f32 v242, v228, v232
    v_mul_f32 v243, v229, v232
    v_cvt_pk_bf16_f32 v244, v240, v241
    v_mfma_f32_16x16x32_bf16 v[204:207], v[40:43], v[40:43], v[204:207]
    ds_read_b128 v[96:99], v181 offset:32768
    v_lshlrev_b32 v240, 16, v244
    v_and_b32 v241, 0xffff0000, v244
    v_cvt_pk_bf16_f32 v245, v242, v243
    v_lshlrev_b32 v242, 16, v245
    ds_read_b128 v[100:103], v193 offset:32768
    v_mfma_f32_16x16x32_bf16 v[136:139], v[72:75], v[48:51], v[136:139]
    v_and_b32 v243, 0xffff0000, v245
    v_add_f32 v236, v236, v240
    v_add_f32 v237, v237, v241
    v_add_f32 v238, v238, v242
    v_add_f32 v239, v239, v243
    v_mfma_f32_16x16x32_bf16 v[152:155], v[72:75], v[52:55], v[152:155]
    s_add_u32 m0, s53, 0
    s_add_u32 s56, s54, 110592
    buffer_load_dwordx4 v15, s[12:15], s54 offen lds
    ds_read_b64_tr_b16 v[120:121], v196 offset:49152
    v_cvt_pk_bf16_f32 v244, v236, v237
    v_lshlrev_b32 v236, 16, v244
    v_and_b32 v237, 0xffff0000, v244
    v_mfma_f32_16x16x32_bf16 v[140:143], v[76:79], v[48:51], v[140:143]
    v_cvt_pk_bf16_f32 v245, v238, v239
    ds_read_b64_tr_b16 v[122:123], v196 offset:51200
    v_lshlrev_b32 v238, 16, v245
    v_and_b32 v239, 0xffff0000, v245
    v_mul_f32 v240, v227, v231
    v_mul_f32 v241, v228, v231
    v_mfma_f32_16x16x32_bf16 v[156:159], v[76:79], v[52:55], v[156:159]
    v_mul_f32 v242, v229, v231
    ds_read_b64_tr_b16 v[124:125], v197 offset:49152
    v_mul_f32 v243, v230, v231
    v_cvt_pk_bf16_f32 v244, v240, v241
    v_lshlrev_b32 v240, 16, v244
    v_mfma_f32_16x16x32_bf16 v[144:147], v[80:83], v[48:51], v[144:147]
    v_and_b32 v241, 0xffff0000, v244
    v_cvt_pk_bf16_f32 v245, v242, v243
    ds_read_b64_tr_b16 v[126:127], v197 offset:51200
    v_lshlrev_b32 v242, 16, v245
    v_and_b32 v243, 0xffff0000, v245
    v_mfma_f32_16x16x32_bf16 v[160:163], v[80:83], v[52:55], v[160:163]
    v_add_f32 v236, v236, v240
    v_add_f32 v237, v237, v241
    ds_read_b64_tr_b16 v[128:129], v198 offset:49152
    v_add_f32 v238, v238, v242
    v_add_f32 v239, v239, v243
    v_mfma_f32_16x16x32_bf16 v[176:179], v[28:31], v[48:51], v[176:179]
    v_cvt_pk_bf16_f32 v244, v236, v237
    v_lshlrev_b32 v236, 16, v244
    v_and_b32 v237, 0xffff0000, v244
    s_add_u32 m0, s53, 8192
    s_add_u32 s58, s58, 1
    buffer_load_dwordx4 v15, s[12:15], s56 offen lds
    s_cmp_eq_u32 s58, 10
    s_cselect_b32 s58, 0, s58
    ds_read_b64_tr_b16 v[130:131], v198 offset:51200
    v_cvt_pk_bf16_f32 v245, v238, v239
    v_mfma_f32_16x16x32_bf16 v[148:151], v[84:87], v[48:51], v[148:151]
    v_lshlrev_b32 v238, 16, v245
    v_and_b32 v239, 0xffff0000, v245
    v_and_b32 v240, 0xffff0000, v216
    ds_read_b64_tr_b16 v[132:133], v199 offset:49152
    v_and_b32 v241, 0xffff0000, v217
    v_mfma_f32_16x16x32_bf16 v[164:167], v[84:87], v[52:55], v[164:167]
    v_and_b32 v242, 0xffff0000, v218
    v_and_b32 v243, 0xffff0000, v219
    v_mul_f32 v236, v236, v240
    v_mul_f32 v237, v237, v241
    ds_read_b64_tr_b16 v[134:135], v199 offset:51200
    v_mfma_f32_16x16x32_bf16 v[204:207], v[48:51], v[48:51], v[204:207]
    v_mul_f32 v238, v238, v242
    v_mul_f32 v239, v239, v243
    v_cvt_pk_bf16_f32 v246, v239, v238
    v_cvt_pk_bf16_f32 v247, v237, v236
    ds_write_b64 v11, v[246:247] offset:136
    s_waitcnt vmcnt(8) lgkmcnt(0)
    s_barrier
    v_mfma_f32_16x16x32_bf16 v[136:139], v[104:107], v[88:91], v[136:139]
    ds_read_b64 v[208:209], v12
    ds_read_b64 v[210:211], v12 offset:8
    s_waitcnt lgkmcnt(0)
    buffer_store_dwordx4 v[208:211], v37, s[28:31], s34 offen sc1
    ds_read_b128 v[40:43], v182 offset:0
    v_mfma_f32_16x16x32_bf16 v[152:155], v[104:107], v[92:95], v[152:155]
    ds_read_b128 v[44:47], v194 offset:0
    v_mfma_f32_16x16x32_bf16 v[168:171], v[104:107], v[28:31], v[168:171]
    s_add_u32 m0, s52, 32768
    s_lshl_b32 s55, s58, 7
    buffer_load_dwordx4 v18, s[8:11], s55 offen lds
    v_mfma_f32_16x16x32_bf16 v[140:143], v[108:111], v[88:91], v[140:143]
    ds_read_b64_tr_b16 v[56:57], v188 offset:16384
    v_mfma_f32_16x16x32_bf16 v[156:159], v[108:111], v[92:95], v[156:159]
    ds_read_b64_tr_b16 v[58:59], v188 offset:18432
    v_mfma_f32_16x16x32_bf16 v[172:175], v[108:111], v[28:31], v[172:175]
    ds_read_b64_tr_b16 v[60:61], v189 offset:16384
    v_mfma_f32_16x16x32_bf16 v[144:147], v[112:115], v[88:91], v[144:147]
    ds_read_b64_tr_b16 v[62:63], v189 offset:18432
    v_mfma_f32_16x16x32_bf16 v[160:163], v[112:115], v[92:95], v[160:163]
    ds_read_b64_tr_b16 v[64:65], v190 offset:16384
    s_add_u32 m0, s52, 33792
    s_mul_i32 s54, s58, 221184
    buffer_load_dwordx4 v19, s[8:11], s55 offen lds
    v_mfma_f32_16x16x32_bf16 v[176:179], v[28:31], v[88:91], v[176:179]
    ds_read_b64_tr_b16 v[66:67], v190 offset:18432
    v_mfma_f32_16x16x32_bf16 v[148:151], v[116:119], v[88:91], v[148:151]
    ds_read_b64_tr_b16 v[68:69], v191 offset:16384
    v_mfma_f32_16x16x32_bf16 v[164:167], v[116:119], v[92:95], v[164:167]
    ds_read_b64_tr_b16 v[70:71], v191 offset:18432
    v_mfma_f32_16x16x32_bf16 v[204:207], v[88:91], v[88:91], v[204:207]
    ds_read_b128 v[48:51], v183 offset:0
    v_mfma_f32_16x16x32_bf16 v[136:139], v[120:123], v[96:99], v[136:139]
    ds_read_b128 v[52:55], v195 offset:0
    v_mfma_f32_16x16x32_bf16 v[152:155], v[120:123], v[100:103], v[152:155]
    s_add_u32 m0, s53, 32768
    s_add_u32 s56, s54, 110592
    buffer_load_dwordx4 v15, s[12:15], s54 offen lds
    v_mfma_f32_16x16x32_bf16 v[140:143], v[124:127], v[96:99], v[140:143]
    ds_read_b64_tr_b16 v[72:73], v200 offset:16384
    ds_read_b64_tr_b16 v[74:75], v200 offset:18432
    v_mfma_f32_16x16x32_bf16 v[156:159], v[124:127], v[100:103], v[156:159]
    ds_read_b64_tr_b16 v[76:77], v201 offset:16384
    v_mfma_f32_16x16x32_bf16 v[144:147], v[128:131], v[96:99], v[144:147]
    ds_read_b64_tr_b16 v[78:79], v201 offset:18432
    v_mfma_f32_16x16x32_bf16 v[160:163], v[128:131], v[100:103], v[160:163]
    ds_read_b64_tr_b16 v[80:81], v202 offset:16384
    v_mfma_f32_16x16x32_bf16 v[176:179], v[28:31], v[96:99], v[176:179]
    s_add_u32 m0, s53, 40960
    s_add_u32 s58, s58, 1
    buffer_load_dwordx4 v15, s[12:15], s56 offen lds
    s_cmp_eq_u32 s58, 10
    s_cselect_b32 s58, 0, s58
    v_mfma_f32_16x16x32_bf16 v[148:151], v[132:135], v[96:99], v[148:151]
    ds_read_b64_tr_b16 v[82:83], v202 offset:18432
    v_mfma_f32_16x16x32_bf16 v[164:167], v[132:135], v[100:103], v[164:167]
    ds_read_b64_tr_b16 v[84:85], v203 offset:16384
    v_mfma_f32_16x16x32_bf16 v[204:207], v[96:99], v[96:99], v[204:207]
    ds_read_b64_tr_b16 v[86:87], v203 offset:18432
    s_waitcnt vmcnt(9) lgkmcnt(0)
    s_barrier
    v_mfma_f32_16x16x32_bf16 v[136:139], v[56:59], v[40:43], v[136:139]
    ds_read_b128 v[88:91], v182 offset:32768
    v_mfma_f32_16x16x32_bf16 v[152:155], v[56:59], v[44:47], v[152:155]
    ds_read_b128 v[92:95], v194 offset:32768
    v_mfma_f32_16x16x32_bf16 v[168:171], v[56:59], v[28:31], v[168:171]
    ds_read_b64_tr_b16 v[104:105], v188 offset:49152
    v_mfma_f32_16x16x32_bf16 v[140:143], v[60:63], v[40:43], v[140:143]
    ds_read_b64_tr_b16 v[106:107], v188 offset:51200
    v_mfma_f32_16x16x32_bf16 v[156:159], v[60:63], v[44:47], v[156:159]
    ds_read_b64_tr_b16 v[108:109], v189 offset:49152
    v_mfma_f32_16x16x32_bf16 v[172:175], v[60:63], v[28:31], v[172:175]
    ds_read_b64_tr_b16 v[110:111], v189 offset:51200
    v_mfma_f32_16x16x32_bf16 v[144:147], v[64:67], v[40:43], v[144:147]
    ds_read_b64_tr_b16 v[112:113], v190 offset:49152
    v_mfma_f32_16x16x32_bf16 v[160:163], v[64:67], v[44:47], v[160:163]
    ds_read_b64_tr_b16 v[114:115], v190 offset:51200
    v_mfma_f32_16x16x32_bf16 v[176:179], v[28:31], v[40:43], v[176:179]
    ds_read_b64_tr_b16 v[116:117], v191 offset:49152
    v_mfma_f32_16x16x32_bf16 v[148:151], v[68:71], v[40:43], v[148:151]
    ds_read_b64_tr_b16 v[118:119], v191 offset:51200
    v_mfma_f32_16x16x32_bf16 v[164:167], v[68:71], v[44:47], v[164:167]
    v_mfma_f32_16x16x32_bf16 v[204:207], v[40:43], v[40:43], v[204:207]
    ds_read_b128 v[96:99], v183 offset:32768
    v_mfma_f32_16x16x32_bf16 v[136:139], v[72:75], v[48:51], v[136:139]
    ds_read_b128 v[100:103], v195 offset:32768
    v_mfma_f32_16x16x32_bf16 v[152:155], v[72:75], v[52:55], v[152:155]
    ds_read_b64_tr_b16 v[120:121], v200 offset:49152
    v_mfma_f32_16x16x32_bf16 v[140:143], v[76:79], v[48:51], v[140:143]
    ds_read_b64_tr_b16 v[122:123], v200 offset:51200
    v_mfma_f32_16x16x32_bf16 v[156:159], v[76:79], v[52:55], v[156:159]
    ds_read_b64_tr_b16 v[124:125], v201 offset:49152
    v_mfma_f32_16x16x32_bf16 v[144:147], v[80:83], v[48:51], v[144:147]
    ds_read_b64_tr_b16 v[126:127], v201 offset:51200
    v_mfma_f32_16x16x32_bf16 v[160:163], v[80:83], v[52:55], v[160:163]
    ds_read_b64_tr_b16 v[128:129], v202 offset:49152
    v_mfma_f32_16x16x32_bf16 v[176:179], v[28:31], v[48:51], v[176:179]
    ds_read_b64_tr_b16 v[130:131], v202 offset:51200
    v_mfma_f32_16x16x32_bf16 v[148:151], v[84:87], v[48:51], v[148:151]
    ds_read_b64_tr_b16 v[132:133], v203 offset:49152
    v_mfma_f32_16x16x32_bf16 v[164:167], v[84:87], v[52:55], v[164:167]
    ds_read_b64_tr_b16 v[134:135], v203 offset:51200
    v_mfma_f32_16x16x32_bf16 v[204:207], v[48:51], v[48:51], v[204:207]
    s_waitcnt vmcnt(4) lgkmcnt(0)
    s_barrier
    v_mfma_f32_16x16x32_bf16 v[136:139], v[104:107], v[88:91], v[136:139]
    s_cmp_lg_u32 s3, 7
    s_cbranch_scc1 F_AI1
    s_mov_b32 s94, 0
F_AIW1:
    v_readfirstlane_b32 s48, v249
    s_cmp_eq_u32 s48, 1
    s_cbranch_scc1 F_AIG1
    s_sleep 8
    v_mov_b32 v248, 0
    buffer_load_dword v249, v248, s[96:99], 0 offen sc1
    s_waitcnt vmcnt(0)
    s_add_u32 s94, s94, 1
    s_cmp_lt_u32 s94, 0x100000
    s_cbranch_scc1 F_AIW1
F_AIG1:
    s_lshl_b32 s48, s4, 8
    s_add_u32 s48, s48, 16973824
    v_mov_b32 v248, s48
    v_mov_b32 v249, 1
    s_mov_b64 exec, 1
    buffer_atomic_add v249, v248, s[28:31], 0 offen sc0 sc1
    s_mov_b64 exec, -1
F_AI1:
    v_mfma_f32_16x16x32_bf16 v[152:155], v[104:107], v[92:95], v[152:155]
    ds_read_b128 v[40:43], v180 offset:0
    v_mfma_f32_16x16x32_bf16 v[168:171], v[104:107], v[28:31], v[168:171]
    ds_read_b128 v[44:47], v192 offset:0
    v_mfma_f32_16x16x32_bf16 v[140:143], v[108:111], v[88:91], v[140:143]
    ds_read_b64_tr_b16 v[56:57], v184 offset:16384
    v_mfma_f32_16x16x32_bf16 v[156:159], v[108:111], v[92:95], v[156:159]
    ds_read_b64_tr_b16 v[58:59], v184 offset:18432
    v_mfma_f32_16x16x32_bf16 v[172:175], v[108:111], v[28:31], v[172:175]
    ds_read_b64_tr_b16 v[60:61], v185 offset:16384
    v_mfma_f32_16x16x32_bf16 v[144:147], v[112:115], v[88:91], v[144:147]
    ds_read_b64_tr_b16 v[62:63], v185 offset:18432
    v_mfma_f32_16x16x32_bf16 v[160:163], v[112:115], v[92:95], v[160:163]
    ds_read_b64_tr_b16 v[64:65], v186 offset:16384
    v_mfma_f32_16x16x32_bf16 v[176:179], v[28:31], v[88:91], v[176:179]
    ds_read_b64_tr_b16 v[66:67], v186 offset:18432
    v_mfma_f32_16x16x32_bf16 v[148:151], v[116:119], v[88:91], v[148:151]
    ds_read_b64_tr_b16 v[68:69], v187 offset:16384
    v_mfma_f32_16x16x32_bf16 v[164:167], v[116:119], v[92:95], v[164:167]
    ds_read_b64_tr_b16 v[70:71], v187 offset:18432
    v_mfma_f32_16x16x32_bf16 v[204:207], v[88:91], v[88:91], v[204:207]
    ds_read_b128 v[48:51], v181 offset:0
    v_mfma_f32_16x16x32_bf16 v[136:139], v[120:123], v[96:99], v[136:139]
    ds_read_b128 v[52:55], v193 offset:0
    v_mfma_f32_16x16x32_bf16 v[152:155], v[120:123], v[100:103], v[152:155]
    ds_read_b64_tr_b16 v[72:73], v196 offset:16384
    v_mfma_f32_16x16x32_bf16 v[140:143], v[124:127], v[96:99], v[140:143]
    ds_read_b64_tr_b16 v[74:75], v196 offset:18432
    v_mfma_f32_16x16x32_bf16 v[156:159], v[124:127], v[100:103], v[156:159]
    ds_read_b64_tr_b16 v[76:77], v197 offset:16384
    v_mfma_f32_16x16x32_bf16 v[144:147], v[128:131], v[96:99], v[144:147]
    ds_read_b64_tr_b16 v[78:79], v197 offset:18432
    v_mfma_f32_16x16x32_bf16 v[160:163], v[128:131], v[100:103], v[160:163]
    ds_read_b64_tr_b16 v[80:81], v198 offset:16384
    v_mfma_f32_16x16x32_bf16 v[176:179], v[28:31], v[96:99], v[176:179]
    ds_read_b64_tr_b16 v[82:83], v198 offset:18432
    v_mfma_f32_16x16x32_bf16 v[148:151], v[132:135], v[96:99], v[148:151]
    ds_read_b64_tr_b16 v[84:85], v199 offset:16384
    v_mfma_f32_16x16x32_bf16 v[164:167], v[132:135], v[100:103], v[164:167]
    ds_read_b64_tr_b16 v[86:87], v199 offset:18432
    v_mfma_f32_16x16x32_bf16 v[204:207], v[96:99], v[96:99], v[204:207]
    s_waitcnt vmcnt(0) lgkmcnt(0)
    s_barrier
    v_mfma_f32_16x16x32_bf16 v[136:139], v[56:59], v[40:43], v[136:139]
    ds_read_b128 v[88:91], v180 offset:32768
    v_mfma_f32_16x16x32_bf16 v[152:155], v[56:59], v[44:47], v[152:155]
    ds_read_b128 v[92:95], v192 offset:32768
    v_mfma_f32_16x16x32_bf16 v[168:171], v[56:59], v[28:31], v[168:171]
    ds_read_b64_tr_b16 v[104:105], v184 offset:49152
    v_mfma_f32_16x16x32_bf16 v[140:143], v[60:63], v[40:43], v[140:143]
    ds_read_b64_tr_b16 v[106:107], v184 offset:51200
    v_mfma_f32_16x16x32_bf16 v[156:159], v[60:63], v[44:47], v[156:159]
    s_cmp_lg_u32 s3, 7
    s_cbranch_scc1 F_AC2
    s_waitcnt vmcnt(0)
    v_readfirstlane_b32 s62, v249
    s_cmp_lg_u32 s62, 31
    s_cbranch_scc1 F_AC2
    v_lshlrev_b32 v248, 7, v2
    s_lshl_b32 s62, s4, 2
    s_add_u32 s62, s62, 16990208
    v_add_u32 v248, s62, v248
    v_mov_b32 v249, 1
    s_movk_i32 s62, 0x2000
    s_movk_i32 s63, 0x4000
    buffer_store_dword v249, v248, s[28:31], 0 offen sc1
    buffer_store_dword v249, v248, s[28:31], s62 offen sc1
    buffer_store_dword v249, v248, s[28:31], s63 offen sc1
    s_movk_i32 s62, 0x6000
    s_nop 0
    buffer_store_dword v249, v248, s[28:31], s62 offen sc1
F_AC2:
    v_mfma_f32_16x16x32_bf16 v[172:175], v[60:63], v[28:31], v[172:175]
    ds_read_b64_tr_b16 v[108:109], v185 offset:49152
    v_mfma_f32_16x16x32_bf16 v[144:147], v[64:67], v[40:43], v[144:147]
    ds_read_b64_tr_b16 v[110:111], v185 offset:51200
    v_mfma_f32_16x16x32_bf16 v[160:163], v[64:67], v[44:47], v[160:163]
    ds_read_b64_tr_b16 v[112:113], v186 offset:49152
    v_mfma_f32_16x16x32_bf16 v[176:179], v[28:31], v[40:43], v[176:179]
    ds_read_b64_tr_b16 v[114:115], v186 offset:51200
    v_mfma_f32_16x16x32_bf16 v[148:151], v[68:71], v[40:43], v[148:151]
    ds_read_b64_tr_b16 v[116:117], v187 offset:49152
    v_mfma_f32_16x16x32_bf16 v[164:167], v[68:71], v[44:47], v[164:167]
    ds_read_b64_tr_b16 v[118:119], v187 offset:51200
    v_mfma_f32_16x16x32_bf16 v[204:207], v[40:43], v[40:43], v[204:207]
    ds_read_b128 v[96:99], v181 offset:32768
    v_mfma_f32_16x16x32_bf16 v[136:139], v[72:75], v[48:51], v[136:139]
    ds_read_b128 v[100:103], v193 offset:32768
    v_mfma_f32_16x16x32_bf16 v[152:155], v[72:75], v[52:55], v[152:155]
    ds_read_b64_tr_b16 v[120:121], v196 offset:49152
    v_mfma_f32_16x16x32_bf16 v[140:143], v[76:79], v[48:51], v[140:143]
    ds_read_b64_tr_b16 v[122:123], v196 offset:51200
    v_mfma_f32_16x16x32_bf16 v[156:159], v[76:79], v[52:55], v[156:159]
    ds_read_b64_tr_b16 v[124:125], v197 offset:49152
    v_mfma_f32_16x16x32_bf16 v[144:147], v[80:83], v[48:51], v[144:147]
    ds_read_b64_tr_b16 v[126:127], v197 offset:51200
    v_mfma_f32_16x16x32_bf16 v[160:163], v[80:83], v[52:55], v[160:163]
    ds_read_b64_tr_b16 v[128:129], v198 offset:49152
    v_mfma_f32_16x16x32_bf16 v[176:179], v[28:31], v[48:51], v[176:179]
    ds_read_b64_tr_b16 v[130:131], v198 offset:51200
    v_mfma_f32_16x16x32_bf16 v[148:151], v[84:87], v[48:51], v[148:151]
    ds_read_b64_tr_b16 v[132:133], v199 offset:49152
    v_mfma_f32_16x16x32_bf16 v[164:167], v[84:87], v[52:55], v[164:167]
    ds_read_b64_tr_b16 v[134:135], v199 offset:51200
    v_mfma_f32_16x16x32_bf16 v[204:207], v[48:51], v[48:51], v[204:207]
    s_waitcnt lgkmcnt(0)
    v_mfma_f32_16x16x32_bf16 v[136:139], v[104:107], v[88:91], v[136:139]
    v_mfma_f32_16x16x32_bf16 v[152:155], v[104:107], v[92:95], v[152:155]
    v_mfma_f32_16x16x32_bf16 v[168:171], v[104:107], v[28:31], v[168:171]
    v_mfma_f32_16x16x32_bf16 v[140:143], v[108:111], v[88:91], v[140:143]
    v_mfma_f32_16x16x32_bf16 v[156:159], v[108:111], v[92:95], v[156:159]
    v_mfma_f32_16x16x32_bf16 v[172:175], v[108:111], v[28:31], v[172:175]
    v_mfma_f32_16x16x32_bf16 v[144:147], v[112:115], v[88:91], v[144:147]
    v_mfma_f32_16x16x32_bf16 v[160:163], v[112:115], v[92:95], v[160:163]
    v_mfma_f32_16x16x32_bf16 v[176:179], v[28:31], v[88:91], v[176:179]
    v_mfma_f32_16x16x32_bf16 v[148:151], v[116:119], v[88:91], v[148:151]
    v_mfma_f32_16x16x32_bf16 v[164:167], v[116:119], v[92:95], v[164:167]
    v_mfma_f32_16x16x32_bf16 v[204:207], v[88:91], v[88:91], v[204:207]
    v_mfma_f32_16x16x32_bf16 v[136:139], v[120:123], v[96:99], v[136:139]
    v_mfma_f32_16x16x32_bf16 v[152:155], v[120:123], v[100:103], v[152:155]
    v_mfma_f32_16x16x32_bf16 v[140:143], v[124:127], v[96:99], v[140:143]
    v_mfma_f32_16x16x32_bf16 v[156:159], v[124:127], v[100:103], v[156:159]
    v_mfma_f32_16x16x32_bf16 v[144:147], v[128:131], v[96:99], v[144:147]
    v_mfma_f32_16x16x32_bf16 v[160:163], v[128:131], v[100:103], v[160:163]
    v_mfma_f32_16x16x32_bf16 v[176:179], v[28:31], v[96:99], v[176:179]
    v_mfma_f32_16x16x32_bf16 v[148:151], v[132:135], v[96:99], v[148:151]
    v_mfma_f32_16x16x32_bf16 v[164:167], v[132:135], v[100:103], v[164:167]
    v_mfma_f32_16x16x32_bf16 v[204:207], v[96:99], v[96:99], v[204:207]
    s_lshl_b32 s48, s32, 8
    s_lshl_b32 s49, s33, 7
    s_add_u32 s48, s48, s49
    v_lshlrev_b32 v3, 3, v16
    v_add_u32 v3, s48, v3
    v_add_u32 v3, 131072, v3
    v_xor_b32 v7, 0x80, v3
    v_and_b32 v4, 3, v16
    v_cmp_eq_u32 vcc, 1, v4
    s_nop 1
    v_cndmask_b32 v177, v204, v205, vcc
    v_cmp_eq_u32 vcc, 2, v4
    s_nop 1
    v_cndmask_b32 v177, v177, v206, vcc
    v_cmp_eq_u32 vcc, 3, v4
    s_nop 1
    v_cndmask_b32 v177, v177, v207, vcc
    v_lshrrev_b32 v4, 2, v16
    v_cmp_eq_u32 vcc, v4, v17
    s_and_saveexec_b64 s[56:57], vcc
    ds_write_b64 v3, v[176:177]
    s_mov_b64 exec, s[56:57]
    s_lshl_b32 s48, s33, 9
    s_and_b32 s49, s32, 2
    s_lshl_b32 s49, s49, 7
    s_add_u32 s48, s48, s49
    v_lshlrev_b32 v5, 4, v17
    v_add_u32 v5, s48, v5
    v_add_u32 v5, 132096, v5
    v_xor_b32 v8, 0x100, v5
    s_and_b32 s49, s32, 1
    s_lshl_b32 s49, s49, 6
    v_add_u32 v6, s49, v5
    v_cmp_eq_u32 vcc, 0, v16
    s_and_saveexec_b64 s[56:57], vcc
    ds_write_b128 v6, v[168:171] offset:0
    ds_write_b128 v6, v[172:175] offset:128
    s_mov_b64 exec, s[56:57]
    s_waitcnt lgkmcnt(0)
    s_barrier
    s_cmp_lt_i32 s100, 0
    s_cbranch_scc1 F_CL3
    s_mov_b32 s16, s68
    s_and_b32 s17, s69, 0xffff
    s_mov_b32 s18, 2621440
    s_mov_b32 s19, 0x00020000
    s_lshl_b32 s101, s100, 12
    v_lshlrev_b32 v39, 4, v2
    buffer_load_dwordx4 v[180:183], v39, s[16:19], s101 offen offset:0
    buffer_load_dwordx4 v[184:187], v39, s[16:19], s101 offen offset:4
    buffer_load_dwordx4 v[188:191], v39, s[16:19], s101 offen offset:8
    buffer_load_dwordx4 v[192:195], v39, s[16:19], s101 offen offset:1024
    buffer_load_dwordx4 v[196:199], v39, s[16:19], s101 offen offset:1028
    buffer_load_dwordx4 v[200:203], v39, s[16:19], s101 offen offset:1032
    buffer_load_dwordx4 v[204:207], v39, s[16:19], s101 offen offset:2048
    buffer_load_dwordx4 v[208:211], v39, s[16:19], s101 offen offset:2052
    buffer_load_dwordx4 v[212:215], v39, s[16:19], s101 offen offset:2056
    buffer_load_dwordx4 v[216:219], v39, s[16:19], s101 offen offset:3072
    buffer_load_dwordx4 v[220:223], v39, s[16:19], s101 offen offset:3076
    buffer_load_dwordx4 v[224:227], v39, s[16:19], s101 offen offset:3080
F_CL3:
    s_cmp_lt_i32 s100, 0
    s_cbranch_scc1 F_NOPRIO
    s_setprio 2
F_NOPRIO:
    s_mov_b32 s35, 0
    ds_read_b64 v[40:41], v3
    ds_read_b64 v[48:49], v7
    ds_read_b128 v[56:59], v5 offset:0
    ds_read_b128 v[60:63], v5 offset:64
    ds_read_b128 v[64:67], v5 offset:128
    ds_read_b128 v[68:71], v5 offset:192
    ds_read_b128 v[72:75], v8 offset:0
    ds_read_b128 v[76:79], v8 offset:64
    ds_read_b128 v[80:83], v8 offset:128
    ds_read_b128 v[84:87], v8 offset:192
    s_waitcnt lgkmcnt(0)
    s_cmp_eq_u32 s7, 13
    s_cselect_b32 s48, s33, 0
    s_cmp_lg_u32 s48, 0
    s_cbranch_scc1 F_EPIDONE
    s_mov_b32 s48, 0x3acccccd
    v_mul_f32 v40, s48, v40
    v_mul_f32 v44, s48, v41
    v_fma_f32 v44, -v40, v40, v44
    v_max_f32 v44, 0, v44
    v_cvt_pk_bf16_f32 v41, v40, v44
    v_lshlrev_b32 v40, 16, v41
    v_and_b32 v44, 0xffff0000, v41
    v_add_f32 v44, 0x3727c5ac, v44
    v_cvt_pk_bf16_f32 v41, v44, v44
    v_lshlrev_b32 v44, 16, v41
    v_sqrt_f32 v44, v44
    s_nop 0
    v_cvt_pk_bf16_f32 v41, v44, v44
    v_lshlrev_b32 v41, 16, v41
    v_rcp_f32 v42, v41
    v_sub_f32 v44, 0, v40
    v_mov_b32 v43, v42
    v_mov_b32 v45, v44
    s_mov_b32 s48, 0x3acccccd
    v_mul_f32 v48, s48, v48
    v_mul_f32 v52, s48, v49
    v_fma_f32 v52, -v48, v48, v52
    v_max_f32 v52, 0, v52
    v_cvt_pk_bf16_f32 v49, v48, v52
    v_lshlrev_b32 v48, 16, v49
    v_and_b32 v52, 0xffff0000, v49
    v_add_f32 v52, 0x3727c5ac, v52
    v_cvt_pk_bf16_f32 v49, v52, v52
    v_lshlrev_b32 v52, 16, v49
    v_sqrt_f32 v52, v52
    s_nop 0
    v_cvt_pk_bf16_f32 v49, v52, v52
    v_lshlrev_b32 v49, 16, v49
    v_rcp_f32 v50, v49
    v_sub_f32 v52, 0, v48
    v_mov_b32 v51, v50
    v_mov_b32 v53, v52
    s_lshl_b32 s50, s6, 7
    s_lshl_b32 s48, s32, 5
    s_add_u32 s50, s50, s48
    s_cmp_lg_u32 s7, 0
    s_cbranch_scc1 K1_NOST
    s_lshl_b32 s48, s33, 4
    s_add_u32 s48, s48, s50
    v_add_u32 v9, s48, v16
    v_lshlrev_b32 v9, 3, v9
    v_add_u32 v9, 13631488, v9
    v_cmp_gt_u32 vcc, 16, v2
    v_mov_b32 v10, 0x80000000
    s_nop 0
    v_cndmask_b32 v9, v10, v9, vcc
    buffer_store_dwordx2 v[40:41], v9, s[28:31], 0 offen sc1
K1_NOST:
    v_pk_add_f32 v[56:57], v[56:57], v[60:61]
    v_pk_add_f32 v[58:59], v[58:59], v[62:63]
    v_pk_add_f32 v[64:65], v[64:65], v[68:69]
    v_pk_add_f32 v[66:67], v[66:67], v[70:71]
    v_pk_add_f32 v[72:73], v[72:73], v[76:77]
    v_pk_add_f32 v[74:75], v[74:75], v[78:79]
    v_pk_add_f32 v[80:81], v[80:81], v[84:85]
    v_pk_add_f32 v[82:83], v[82:83], v[86:87]
    s_lshl_b32 s48, s6, 1
    s_lshr_b32 s49, s32, 1
    s_add_u32 s48, s48, s49
    s_mul_i32 s48, s48, 54
    s_lshl_b32 s50, s7, 2
    s_add_u32 s48, s48, s50
    s_lshl_b32 s50, s33, 1
    s_add_u32 s48, s48, s50
    s_add_u32 s48, s48, s49
    s_lshl_b32 s48, s48, 12
    s_and_b32 s50, s32, 1
    s_lshl_b32 s50, s50, 11
    s_add_u32 s48, s48, s50
    s_lshl_b32 s50, s33, 10
    s_add_u32 s48, s48, s50
    s_xor_b32 s49, s48, 0x1000
    s_xor_b32 s50, s48, 0x400
    s_xor_b32 s51, s49, 0x400
    s_mov_b32 s58, 0xbfb8aa3b
    s_mov_b32 s59, 0xbfb8aa3b
    v_lshlrev_b32 v31, 4, v2
    v_pk_fma_f32 v[136:137], v[44:45], v[56:57], v[136:137]
    v_pk_mul_f32 v[136:137], v[136:137], v[42:43]
    v_pk_fma_f32 v[138:139], v[44:45], v[58:59], v[138:139]
    v_pk_mul_f32 v[138:139], v[138:139], v[42:43]
    v_cvt_pk_bf16_f32 v88, v136, v137
    v_lshlrev_b32 v136, 16, v88
    v_and_b32 v137, 0xffff0000, v88
    v_cvt_pk_bf16_f32 v89, v138, v139
    v_lshlrev_b32 v138, 16, v89
    v_and_b32 v139, 0xffff0000, v89
    v_pk_mul_f32 v[90:91], v[136:137], s[58:59]
    v_pk_mul_f32 v[92:93], v[138:139], s[58:59]
    v_exp_f32 v90, v90
    v_exp_f32 v91, v91
    v_exp_f32 v92, v92
    v_exp_f32 v93, v93
    v_pk_add_f32 v[90:91], v[90:91], 1.0 op_sel_hi:[1,0]
    v_pk_add_f32 v[92:93], v[92:93], 1.0 op_sel_hi:[1,0]
    v_rcp_f32 v90, v90
    v_rcp_f32 v91, v91
    v_rcp_f32 v92, v92
    v_rcp_f32 v93, v93
    v_pk_mul_f32 v[90:91], v[90:91], v[136:137]
    v_pk_mul_f32 v[92:93], v[92:93], v[138:139]
    v_cvt_pk_bf16_f32 v96, v90, v91
    v_cvt_pk_bf16_f32 v97, v92, v93
    v_pk_fma_f32 v[140:141], v[44:45], v[64:65], v[140:141]
    v_pk_mul_f32 v[140:141], v[140:141], v[42:43]
    v_pk_fma_f32 v[142:143], v[44:45], v[66:67], v[142:143]
    v_pk_mul_f32 v[142:143], v[142:143], v[42:43]
    v_cvt_pk_bf16_f32 v88, v140, v141
    v_lshlrev_b32 v140, 16, v88
    v_and_b32 v141, 0xffff0000, v88
    v_cvt_pk_bf16_f32 v89, v142, v143
    v_lshlrev_b32 v142, 16, v89
    v_and_b32 v143, 0xffff0000, v89
    v_pk_mul_f32 v[90:91], v[140:141], s[58:59]
    v_pk_mul_f32 v[92:93], v[142:143], s[58:59]
    v_exp_f32 v90, v90
    v_exp_f32 v91, v91
    v_exp_f32 v92, v92
    v_exp_f32 v93, v93
    v_pk_add_f32 v[90:91], v[90:91], 1.0 op_sel_hi:[1,0]
    v_pk_add_f32 v[92:93], v[92:93], 1.0 op_sel_hi:[1,0]
    v_rcp_f32 v90, v90
    v_rcp_f32 v91, v91
    v_rcp_f32 v92, v92
    v_rcp_f32 v93, v93
    v_pk_mul_f32 v[90:91], v[90:91], v[140:141]
    v_pk_mul_f32 v[92:93], v[92:93], v[142:143]
    v_cvt_pk_bf16_f32 v98, v90, v91
    v_cvt_pk_bf16_f32 v99, v92, v93
    s_cmp_ge_i32 s100, 0
    s_cbranch_scc1 F_NOST00
    buffer_store_dwordx4 v[96:99], v31, s[28:31], s48 offen sc1
F_NOST00:
    v_pk_fma_f32 v[144:145], v[44:45], v[72:73], v[144:145]
    v_pk_mul_f32 v[144:145], v[144:145], v[42:43]
    v_pk_fma_f32 v[146:147], v[44:45], v[74:75], v[146:147]
    v_pk_mul_f32 v[146:147], v[146:147], v[42:43]
    v_cvt_pk_bf16_f32 v88, v144, v145
    v_lshlrev_b32 v144, 16, v88
    v_and_b32 v145, 0xffff0000, v88
    v_cvt_pk_bf16_f32 v89, v146, v147
    v_lshlrev_b32 v146, 16, v89
    v_and_b32 v147, 0xffff0000, v89
    v_pk_mul_f32 v[90:91], v[144:145], s[58:59]
    v_pk_mul_f32 v[92:93], v[146:147], s[58:59]
    v_exp_f32 v90, v90
    v_exp_f32 v91, v91
    v_exp_f32 v92, v92
    v_exp_f32 v93, v93
    v_pk_add_f32 v[90:91], v[90:91], 1.0 op_sel_hi:[1,0]
    v_pk_add_f32 v[92:93], v[92:93], 1.0 op_sel_hi:[1,0]
    v_rcp_f32 v90, v90
    v_rcp_f32 v91, v91
    v_rcp_f32 v92, v92
    v_rcp_f32 v93, v93
    v_pk_mul_f32 v[90:91], v[90:91], v[144:145]
    v_pk_mul_f32 v[92:93], v[92:93], v[146:147]
    v_cvt_pk_bf16_f32 v100, v90, v91
    v_cvt_pk_bf16_f32 v101, v92, v93
    v_pk_fma_f32 v[148:149], v[44:45], v[80:81], v[148:149]
    v_pk_mul_f32 v[148:149], v[148:149], v[42:43]
    v_pk_fma_f32 v[150:151], v[44:45], v[82:83], v[150:151]
    v_pk_mul_f32 v[150:151], v[150:151], v[42:43]
    v_cvt_pk_bf16_f32 v88, v148, v149
    v_lshlrev_b32 v148, 16, v88
    v_and_b32 v149, 0xffff0000, v88
    v_cvt_pk_bf16_f32 v89, v150, v151
    v_lshlrev_b32 v150, 16, v89
    v_and_b32 v151, 0xffff0000, v89
    v_pk_mul_f32 v[90:91], v[148:149], s[58:59]
    v_pk_mul_f32 v[92:93], v[150:151], s[58:59]
    v_exp_f32 v90, v90
    v_exp_f32 v91, v91
    v_exp_f32 v92, v92
    v_exp_f32 v93, v93
    v_pk_add_f32 v[90:91], v[90:91], 1.0 op_sel_hi:[1,0]
    v_pk_add_f32 v[92:93], v[92:93], 1.0 op_sel_hi:[1,0]
    v_rcp_f32 v90, v90
    v_rcp_f32 v91, v91
    v_rcp_f32 v92, v92
    v_rcp_f32 v93, v93
    v_pk_mul_f32 v[90:91], v[90:91], v[148:149]
    v_pk_mul_f32 v[92:93], v[92:93], v[150:151]
    v_cvt_pk_bf16_f32 v102, v90, v91
    v_cvt_pk_bf16_f32 v103, v92, v93
    s_cmp_ge_i32 s100, 0
    s_cbranch_scc1 F_NOST01
    buffer_store_dwordx4 v[100:103], v31, s[28:31], s49 offen sc1
F_NOST01:
    v_pk_fma_f32 v[152:153], v[52:53], v[56:57], v[152:153]
    v_pk_mul_f32 v[152:153], v[152:153], v[50:51]
    v_pk_fma_f32 v[154:155], v[52:53], v[58:59], v[154:155]
    v_pk_mul_f32 v[154:155], v[154:155], v[50:51]
    v_cvt_pk_bf16_f32 v88, v152, v153
    v_lshlrev_b32 v152, 16, v88
    v_and_b32 v153, 0xffff0000, v88
    v_cvt_pk_bf16_f32 v89, v154, v155
    v_lshlrev_b32 v154, 16, v89
    v_and_b32 v155, 0xffff0000, v89
    v_pk_mul_f32 v[90:91], v[152:153], s[58:59]
    v_pk_mul_f32 v[92:93], v[154:155], s[58:59]
    v_exp_f32 v90, v90
    v_exp_f32 v91, v91
    v_exp_f32 v92, v92
    v_exp_f32 v93, v93
    v_pk_add_f32 v[90:91], v[90:91], 1.0 op_sel_hi:[1,0]
    v_pk_add_f32 v[92:93], v[92:93], 1.0 op_sel_hi:[1,0]
    v_rcp_f32 v90, v90
    v_rcp_f32 v91, v91
    v_rcp_f32 v92, v92
    v_rcp_f32 v93, v93
    v_pk_mul_f32 v[90:91], v[90:91], v[152:153]
    v_pk_mul_f32 v[92:93], v[92:93], v[154:155]
    v_cvt_pk_bf16_f32 v104, v90, v91
    v_cvt_pk_bf16_f32 v105, v92, v93
    v_pk_fma_f32 v[156:157], v[52:53], v[64:65], v[156:157]
    v_pk_mul_f32 v[156:157], v[156:157], v[50:51]
    v_pk_fma_f32 v[158:159], v[52:53], v[66:67], v[158:159]
    v_pk_mul_f32 v[158:159], v[158:159], v[50:51]
    v_cvt_pk_bf16_f32 v88, v156, v157
    v_lshlrev_b32 v156, 16, v88
    v_and_b32 v157, 0xffff0000, v88
    v_cvt_pk_bf16_f32 v89, v158, v159
    v_lshlrev_b32 v158, 16, v89
    v_and_b32 v159, 0xffff0000, v89
    v_pk_mul_f32 v[90:91], v[156:157], s[58:59]
    v_pk_mul_f32 v[92:93], v[158:159], s[58:59]
    v_exp_f32 v90, v90
    v_exp_f32 v91, v91
    v_exp_f32 v92, v92
    v_exp_f32 v93, v93
    v_pk_add_f32 v[90:91], v[90:91], 1.0 op_sel_hi:[1,0]
    v_pk_add_f32 v[92:93], v[92:93], 1.0 op_sel_hi:[1,0]
    v_rcp_f32 v90, v90
    v_rcp_f32 v91, v91
    v_rcp_f32 v92, v92
    v_rcp_f32 v93, v93
    v_pk_mul_f32 v[90:91], v[90:91], v[156:157]
    v_pk_mul_f32 v[92:93], v[92:93], v[158:159]
    v_cvt_pk_bf16_f32 v106, v90, v91
    v_cvt_pk_bf16_f32 v107, v92, v93
    s_cmp_ge_i32 s100, 0
    s_cbranch_scc1 F_NOST10
    buffer_store_dwordx4 v[104:107], v31, s[28:31], s50 offen sc1
F_NOST10:
    s_cmp_lt_i32 s100, 0
    s_cbranch_scc1 F_NOPOLL1
    v_and_b32 v32, 7, v2
    v_lshlrev_b32 v32, 2, v32
    s_lshl_b32 s62, s2, 7
    s_add_u32 s62, s62, 16990208
    buffer_load_dword v33, v32, s[28:31], s62 offen sc1
F_NOPOLL1:
    v_pk_fma_f32 v[160:161], v[52:53], v[72:73], v[160:161]
    v_pk_mul_f32 v[160:161], v[160:161], v[50:51]
    v_pk_fma_f32 v[162:163], v[52:53], v[74:75], v[162:163]
    v_pk_mul_f32 v[162:163], v[162:163], v[50:51]
    v_cvt_pk_bf16_f32 v88, v160, v161
    v_lshlrev_b32 v160, 16, v88
    v_and_b32 v161, 0xffff0000, v88
    v_cvt_pk_bf16_f32 v89, v162, v163
    v_lshlrev_b32 v162, 16, v89
    v_and_b32 v163, 0xffff0000, v89
    v_pk_mul_f32 v[90:91], v[160:161], s[58:59]
    v_pk_mul_f32 v[92:93], v[162:163], s[58:59]
    v_exp_f32 v90, v90
    v_exp_f32 v91, v91
    v_exp_f32 v92, v92
    v_exp_f32 v93, v93
    v_pk_add_f32 v[90:91], v[90:91], 1.0 op_sel_hi:[1,0]
    v_pk_add_f32 v[92:93], v[92:93], 1.0 op_sel_hi:[1,0]
    v_rcp_f32 v90, v90
    v_rcp_f32 v91, v91
    v_rcp_f32 v92, v92
    v_rcp_f32 v93, v93
    v_pk_mul_f32 v[90:91], v[90:91], v[160:161]
    v_pk_mul_f32 v[92:93], v[92:93], v[162:163]
    v_cvt_pk_bf16_f32 v108, v90, v91
    v_cvt_pk_bf16_f32 v109, v92, v93
    v_pk_fma_f32 v[164:165], v[52:53], v[80:81], v[164:165]
    v_pk_mul_f32 v[164:165], v[164:165], v[50:51]
    v_pk_fma_f32 v[166:167], v[52:53], v[82:83], v[166:167]
    v_pk_mul_f32 v[166:167], v[166:167], v[50:51]
    v_cvt_pk_bf16_f32 v88, v164, v165
    v_lshlrev_b32 v164, 16, v88
    v_and_b32 v165, 0xffff0000, v88
    v_cvt_pk_bf16_f32 v89, v166, v167
    v_lshlrev_b32 v166, 16, v89
    v_and_b32 v167, 0xffff0000, v89
    v_pk_mul_f32 v[90:91], v[164:165], s[58:59]
    v_pk_mul_f32 v[92:93], v[166:167], s[58:59]
    v_exp_f32 v90, v90
    v_exp_f32 v91, v91
    v_exp_f32 v92, v92
    v_exp_f32 v93, v93
    v_pk_add_f32 v[90:91], v[90:91], 1.0 op_sel_hi:[1,0]
    v_pk_add_f32 v[92:93], v[92:93], 1.0 op_sel_hi:[1,0]
    v_rcp_f32 v90, v90
    v_rcp_f32 v91, v91
    v_rcp_f32 v92, v92
    v_rcp_f32 v93, v93
    v_pk_mul_f32 v[90:91], v[90:91], v[164:165]
    v_pk_mul_f32 v[92:93], v[92:93], v[166:167]
    v_cvt_pk_bf16_f32 v110, v90, v91
    v_cvt_pk_bf16_f32 v111, v92, v93
    s_cmp_ge_i32 s100, 0
    s_cbranch_scc1 F_NOST11
    buffer_store_dwordx4 v[108:111], v31, s[28:31], s51 offen sc1
F_NOST11:
    s_cmp_lt_i32 s100, 0
    s_cbranch_scc1 F_EPIDONE
    s_waitcnt vmcnt(0)
    v_cmp_ne_u32 vcc, 1, v33
    s_cmp_lg_u64 vcc, 0
    s_cbranch_scc1 F_HST
    s_sub_u32 s62, s3, 4
    s_mul_i32 s62, s62, 21248
    s_add_u32 m0, s62, 16640
    s_add_u32 s63, s101, 7340032
    s_mov_b32 s35, 1
    v_mov_b32 v32, 160256
    ds_write_b32 v32, v33 offset:8
    buffer_load_dwordx4 v31, s[28:31], s63 offen offset:0 sc1 lds
    buffer_load_dwordx4 v31, s[28:31], s63 offen offset:1024 sc1 lds
    buffer_load_dwordx4 v31, s[28:31], s63 offen offset:2048 sc1 lds
    buffer_load_dwordx4 v31, s[28:31], s63 offen offset:3072 sc1 lds
F_HST:
    buffer_store_dwordx4 v[96:99], v31, s[28:31], s48 offen sc1
    buffer_store_dwordx4 v[100:103], v31, s[28:31], s49 offen sc1
    buffer_store_dwordx4 v[104:107], v31, s[28:31], s50 offen sc1
    buffer_store_dwordx4 v[108:111], v31, s[28:31], s51 offen sc1
F_EPIDONE:
    s_cmp_ge_i32 s100, 0
    s_cbranch_scc1 F_PH2
    s_cmp_lt_u32 s3, 4
    s_cbranch_scc1 F_PH2
    v_mov_b32 v4, 160256
    v_mov_b32 v5, 1
    s_and_b32 s48, s6, 1
    s_lshl_b32 s48, s48, 4
    v_add_u32 v7, s48, v2
    v_lshlrev_b32 v7, 3, v7
    s_lshr_b32 s48, s6, 1
    v_add_u32 v7, s48, v7
    v_lshlrev_b32 v7, 7, v7
    s_lshl_b32 s48, s7, 2
    s_add_u32 s48, s48, 16990240
    v_add_u32 v7, s48, v7
    s_waitcnt vmcnt(0)
    s_mov_b64 exec, 1
    ds_add_rtn_u32 v6, v4, v5
    s_mov_b64 exec, -1
    s_waitcnt lgkmcnt(0)
    v_readfirstlane_b32 s48, v6
    s_cmp_lg_u32 s48, 7
    s_cbranch_scc1 F_HA4
    s_mov_b32 exec_lo, 0xffff
    s_mov_b32 exec_hi, 0
    buffer_store_dword v5, v7, s[28:31], 0 offen sc1
    s_mov_b64 exec, -1
F_HA4:
    s_branch F_PH2
K1_SPARE:
    s_mov_b32 s64, s46
    s_and_b32 s65, s47, 0xffff
    s_mov_b32 s66, 2211840
    s_mov_b32 s67, 0x00020000
    v_and_b32 v15, 7, v13
    v_and_b32 v18, 8, v13
    v_lshlrev_b32 v18, 1, v18
    v_or_b32 v15, v15, v18
    v_and_b32 v18, 16, v13
    v_lshrrev_b32 v18, 1, v18
    v_or_b32 v15, v15, v18
    s_movk_i32 s48, 1280
    v_mul_lo_u32 v15, v15, s48
    v_lshl_add_u32 v15, v14, 4, v15
    s_sub_u32 s48, s5, 28
    s_lshl_b32 s48, s48, 3
    s_add_u32 s76, s48, s4
    s_mul_i32 s54, s76, 40960
    s_lshl_b32 s53, s3, 10
    s_mul_i32 s57, s76, 3
    s_add_u32 s57, s57, 224
    s_nop 0
    s_mul_i32 s48, s57, 205
    s_lshr_b32 s48, s48, 11
    s_mul_i32 s49, s48, 10
    s_sub_u32 s49, s57, s49
    s_lshl_b32 s50, s49, 18
    s_lshl_b32 s51, s48, 7
    s_sub_u32 s77, 7344000, s51
    s_add_u32 s77, s77, s50
    s_mul_i32 s50, s48, 81920
    s_lshl_b32 s51, s49, 7
    s_add_u32 s50, s50, s51
    s_mul_i32 s51, s3, 10240
    s_add_u32 s51, s51, s50
    s_lshl_b32 s62, s3, 10
    s_add_u32 m0, s62, 82944
    s_sub_u32 s63, s50, 10240
    buffer_load_dwordx4 v32, s[16:19], s51 offen lds
    s_add_u32 m0, s62, 91136
    s_cmp_eq_u32 s48, 0
    buffer_load_dwordx4 v32, s[20:23], s51 offen lds
    s_cselect_b32 s63, 0x40000000, s63
    s_mov_b32 m0, 81920
    s_lshl_b32 s49, s49, 9
    buffer_load_dwordx4 v32, s[16:19], s63 offen lds
    buffer_load_dwordx4 v[100:103], v33, s[24:27], s49 offen
    s_add_u32 s57, s57, 1
    s_add_u32 m0, s53, 0
    s_add_u32 s55, s54, 0
    buffer_load_dwordx4 v15, s[64:67], s55 offen lds
    s_add_u32 m0, s53, 8192
    s_add_u32 s55, s54, 256
    buffer_load_dwordx4 v15, s[64:67], s55 offen lds
    s_add_u32 m0, s53, 16384
    s_add_u32 s55, s54, 512
    buffer_load_dwordx4 v15, s[64:67], s55 offen lds
    s_add_u32 m0, s53, 24576
    s_add_u32 s55, s54, 768
    buffer_load_dwordx4 v15, s[64:67], s55 offen lds
    s_add_u32 m0, s53, 32768
    s_add_u32 s55, s54, 1024
    buffer_load_dwordx4 v15, s[64:67], s55 offen lds
    s_add_u32 m0, s53, 40960
    s_add_u32 s55, s54, 1310720
    buffer_load_dwordx4 v15, s[64:67], s55 offen lds
    s_add_u32 m0, s53, 49152
    s_add_u32 s55, s54, 1310976
    buffer_load_dwordx4 v15, s[64:67], s55 offen lds
    s_add_u32 m0, s53, 57344
    s_add_u32 s55, s54, 1311232
    buffer_load_dwordx4 v15, s[64:67], s55 offen lds
    s_add_u32 m0, s53, 65536
    s_add_u32 s55, s54, 1311488
    buffer_load_dwordx4 v15, s[64:67], s55 offen lds
    s_add_u32 m0, s53, 73728
    s_add_u32 s55, s54, 1311744
    buffer_load_dwordx4 v15, s[64:67], s55 offen lds
    s_mul_i32 s48, s57, 205
    s_lshr_b32 s48, s48, 11
    s_mul_i32 s49, s48, 10
    s_sub_u32 s49, s57, s49
    s_lshl_b32 s50, s49, 18
    s_lshl_b32 s51, s48, 7
    s_sub_u32 s78, 7344000, s51
    s_add_u32 s78, s78, s50
    s_mul_i32 s50, s48, 81920
    s_lshl_b32 s51, s49, 7
    s_add_u32 s50, s50, s51
    s_mul_i32 s51, s3, 10240
    s_add_u32 s51, s51, s50
    s_lshl_b32 s62, s3, 10
    s_add_u32 m0, s62, 109056
    s_sub_u32 s63, s50, 10240
    buffer_load_dwordx4 v32, s[16:19], s51 offen lds
    s_add_u32 m0, s62, 117248
    s_cmp_eq_u32 s48, 0
    buffer_load_dwordx4 v32, s[20:23], s51 offen lds
    s_cselect_b32 s63, 0x40000000, s63
    s_mov_b32 m0, 108032
    s_lshl_b32 s49, s49, 9
    buffer_load_dwordx4 v32, s[16:19], s63 offen lds
    buffer_load_dwordx4 v[104:107], v33, s[24:27], s49 offen
    s_add_u32 s57, s57, 1
    s_mul_i32 s48, s57, 205
    s_lshr_b32 s48, s48, 11
    s_mul_i32 s49, s48, 10
    s_sub_u32 s49, s57, s49
    s_lshl_b32 s50, s49, 18
    s_lshl_b32 s51, s48, 7
    s_sub_u32 s79, 7344000, s51
    s_add_u32 s79, s79, s50
    s_mul_i32 s50, s48, 81920
    s_lshl_b32 s51, s49, 7
    s_add_u32 s50, s50, s51
    s_mul_i32 s51, s3, 10240
    s_add_u32 s51, s51, s50
    s_lshl_b32 s62, s3, 10
    s_add_u32 m0, s62, 135168
    s_sub_u32 s63, s50, 10240
    buffer_load_dwordx4 v32, s[16:19], s51 offen lds
    s_add_u32 m0, s62, 143360
    s_cmp_eq_u32 s48, 0
    buffer_load_dwordx4 v32, s[20:23], s51 offen lds
    s_cselect_b32 s63, 0x40000000, s63
    s_mov_b32 m0, 134144
    s_lshl_b32 s49, s49, 9
    buffer_load_dwordx4 v32, s[16:19], s63 offen lds
    buffer_load_dwordx4 v[108:111], v33, s[24:27], s49 offen
    s_add_u32 s57, s57, 1
    s_lshl_b32 s48, s3, 1
    v_add_u32 v25, s48, v24
    v_xor_b32 v25, v25, v22
    v_lshl_add_u32 v25, v25, 4, v23
    v_add_u32 v26, 0x8000, v25
    v_add_u32 v27, 0x10000, v25
    v_lshlrev_b32 v31, 4, v2
    v_add_u32 v40, 82560, v35
    v_add_u32 v41, 91136, v35
    v_add_u32 v42, 81920, v36
    v_add_u32 v43, 81920, v34
    v_add_u32 v44, 108672, v35
    v_add_u32 v45, 117248, v35
    v_add_u32 v46, 108032, v36
    v_add_u32 v47, 108032, v34
    v_add_u32 v48, 134784, v35
    v_add_u32 v49, 143360, v35
    v_add_u32 v50, 134144, v36
    v_add_u32 v51, 134144, v34
    s_waitcnt vmcnt(18)
    s_barrier
    ds_read2_b32 v[208:209], v40 offset0:0 offset1:32
    ds_read2_b32 v[210:211], v40 offset0:64 offset1:96
    ds_read2_b32 v[212:213], v40 offset0:128 offset1:160
    ds_read2_b32 v[214:215], v40 offset0:192 offset1:224
    ds_read2_b32 v[216:217], v41 offset0:0 offset1:32
    ds_read2_b32 v[218:219], v41 offset0:64 offset1:96
    s_waitcnt lgkmcnt(0)
    v_lshlrev_b32 v224, 16, v208
    v_lshlrev_b32 v225, 16, v209
    v_lshlrev_b32 v226, 16, v210
    v_lshlrev_b32 v227, 16, v211
    v_lshlrev_b32 v228, 16, v212
    v_lshlrev_b32 v229, 16, v213
    v_lshlrev_b32 v230, 16, v214
    v_lshlrev_b32 v231, 16, v100
    v_and_b32 v232, 0xffff0000, v100
    v_lshlrev_b32 v233, 16, v101
    v_and_b32 v234, 0xffff0000, v101
    v_mul_f32 v236, v224, v234
    v_mul_f32 v237, v225, v234
    v_mul_f32 v238, v226, v234
    v_mul_f32 v239, v227, v234
    v_cvt_pk_bf16_f32 v244, v236, v237
    v_lshlrev_b32 v236, 16, v244
    v_and_b32 v237, 0xffff0000, v244
    v_cvt_pk_bf16_f32 v245, v238, v239
    v_lshlrev_b32 v238, 16, v245
    v_and_b32 v239, 0xffff0000, v245
    v_mul_f32 v240, v225, v233
    v_mul_f32 v241, v226, v233
    v_mul_f32 v242, v227, v233
    v_mul_f32 v243, v228, v233
    v_cvt_pk_bf16_f32 v244, v240, v241
    v_lshlrev_b32 v240, 16, v244
    v_and_b32 v241, 0xffff0000, v244
    v_cvt_pk_bf16_f32 v245, v242, v243
    v_lshlrev_b32 v242, 16, v245
    v_and_b32 v243, 0xffff0000, v245
    v_add_f32 v236, v236, v240
    v_add_f32 v237, v237, v241
    v_add_f32 v238, v238, v242
    v_add_f32 v239, v239, v243
    v_cvt_pk_bf16_f32 v244, v236, v237
    v_lshlrev_b32 v236, 16, v244
    v_and_b32 v237, 0xffff0000, v244
    v_cvt_pk_bf16_f32 v245, v238, v239
    v_lshlrev_b32 v238, 16, v245
    v_and_b32 v239, 0xffff0000, v245
    v_mul_f32 v240, v226, v232
    v_mul_f32 v241, v227, v232
    v_mul_f32 v242, v228, v232
    v_mul_f32 v243, v229, v232
    v_cvt_pk_bf16_f32 v244, v240, v241
    v_lshlrev_b32 v240, 16, v244
    v_and_b32 v241, 0xffff0000, v244
    v_cvt_pk_bf16_f32 v245, v242, v243
    v_lshlrev_b32 v242, 16, v245
    v_and_b32 v243, 0xffff0000, v245
    v_add_f32 v236, v236, v240
    v_add_f32 v237, v237, v241
    v_add_f32 v238, v238, v242
    v_add_f32 v239, v239, v243
    v_cvt_pk_bf16_f32 v244, v236, v237
    v_lshlrev_b32 v236, 16, v244
    v_and_b32 v237, 0xffff0000, v244
    v_cvt_pk_bf16_f32 v245, v238, v239
    v_lshlrev_b32 v238, 16, v245
    v_and_b32 v239, 0xffff0000, v245
    v_mul_f32 v240, v227, v231
    v_mul_f32 v241, v228, v231
    v_mul_f32 v242, v229, v231
    v_mul_f32 v243, v230, v231
    v_cvt_pk_bf16_f32 v244, v240, v241
    v_lshlrev_b32 v240, 16, v244
    v_and_b32 v241, 0xffff0000, v244
    v_cvt_pk_bf16_f32 v245, v242, v243
    v_lshlrev_b32 v242, 16, v245
    v_and_b32 v243, 0xffff0000, v245
    v_add_f32 v236, v236, v240
    v_add_f32 v237, v237, v241
    v_add_f32 v238, v238, v242
    v_add_f32 v239, v239, v243
    v_cvt_pk_bf16_f32 v244, v236, v237
    v_lshlrev_b32 v236, 16, v244
    v_and_b32 v237, 0xffff0000, v244
    v_cvt_pk_bf16_f32 v245, v238, v239
    v_lshlrev_b32 v238, 16, v245
    v_and_b32 v239, 0xffff0000, v245
    v_lshlrev_b32 v240, 16, v216
    v_lshlrev_b32 v241, 16, v217
    v_lshlrev_b32 v242, 16, v218
    v_lshlrev_b32 v243, 16, v219
    v_mul_f32 v236, v236, v240
    v_mul_f32 v237, v237, v241
    v_mul_f32 v238, v238, v242
    v_mul_f32 v239, v239, v243
    v_cvt_pk_bf16_f32 v246, v239, v238
    v_cvt_pk_bf16_f32 v247, v237, v236
    ds_write_b64 v42, v[246:247] offset:0
    v_and_b32 v224, 0xffff0000, v208
    v_and_b32 v225, 0xffff0000, v209
    v_and_b32 v226, 0xffff0000, v210
    v_and_b32 v227, 0xffff0000, v211
    v_and_b32 v228, 0xffff0000, v212
    v_and_b32 v229, 0xffff0000, v213
    v_and_b32 v230, 0xffff0000, v214
    v_lshlrev_b32 v231, 16, v102
    v_and_b32 v232, 0xffff0000, v102
    v_lshlrev_b32 v233, 16, v103
    v_and_b32 v234, 0xffff0000, v103
    v_mul_f32 v236, v224, v234
    v_mul_f32 v237, v225, v234
    v_mul_f32 v238, v226, v234
    v_mul_f32 v239, v227, v234
    v_cvt_pk_bf16_f32 v244, v236, v237
    v_lshlrev_b32 v236, 16, v244
    v_and_b32 v237, 0xffff0000, v244
    v_cvt_pk_bf16_f32 v245, v238, v239
    v_lshlrev_b32 v238, 16, v245
    v_and_b32 v239, 0xffff0000, v245
    v_mul_f32 v240, v225, v233
    v_mul_f32 v241, v226, v233
    v_mul_f32 v242, v227, v233
    v_mul_f32 v243, v228, v233
    v_cvt_pk_bf16_f32 v244, v240, v241
    v_lshlrev_b32 v240, 16, v244
    v_and_b32 v241, 0xffff0000, v244
    v_cvt_pk_bf16_f32 v245, v242, v243
    v_lshlrev_b32 v242, 16, v245
    v_and_b32 v243, 0xffff0000, v245
    v_add_f32 v236, v236, v240
    v_add_f32 v237, v237, v241
    v_add_f32 v238, v238, v242
    v_add_f32 v239, v239, v243
    v_cvt_pk_bf16_f32 v244, v236, v237
    v_lshlrev_b32 v236, 16, v244
    v_and_b32 v237, 0xffff0000, v244
    v_cvt_pk_bf16_f32 v245, v238, v239
    v_lshlrev_b32 v238, 16, v245
    v_and_b32 v239, 0xffff0000, v245
    v_mul_f32 v240, v226, v232
    v_mul_f32 v241, v227, v232
    v_mul_f32 v242, v228, v232
    v_mul_f32 v243, v229, v232
    v_cvt_pk_bf16_f32 v244, v240, v241
    v_lshlrev_b32 v240, 16, v244
    v_and_b32 v241, 0xffff0000, v244
    v_cvt_pk_bf16_f32 v245, v242, v243
    v_lshlrev_b32 v242, 16, v245
    v_and_b32 v243, 0xffff0000, v245
    v_add_f32 v236, v236, v240
    v_add_f32 v237, v237, v241
    v_add_f32 v238, v238, v242
    v_add_f32 v239, v239, v243
    v_cvt_pk_bf16_f32 v244, v236, v237
    v_lshlrev_b32 v236, 16, v244
    v_and_b32 v237, 0xffff0000, v244
    v_cvt_pk_bf16_f32 v245, v238, v239
    v_lshlrev_b32 v238, 16, v245
    v_and_b32 v239, 0xffff0000, v245
    v_mul_f32 v240, v227, v231
    v_mul_f32 v241, v228, v231
    v_mul_f32 v242, v229, v231
    v_mul_f32 v243, v230, v231
    v_cvt_pk_bf16_f32 v244, v240, v241
    v_lshlrev_b32 v240, 16, v244
    v_and_b32 v241, 0xffff0000, v244
    v_cvt_pk_bf16_f32 v245, v242, v243
    v_lshlrev_b32 v242, 16, v245
    v_and_b32 v243, 0xffff0000, v245
    v_add_f32 v236, v236, v240
    v_add_f32 v237, v237, v241
    v_add_f32 v238, v238, v242
    v_add_f32 v239, v239, v243
    v_cvt_pk_bf16_f32 v244, v236, v237
    v_lshlrev_b32 v236, 16, v244
    v_and_b32 v237, 0xffff0000, v244
    v_cvt_pk_bf16_f32 v245, v238, v239
    v_lshlrev_b32 v238, 16, v245
    v_and_b32 v239, 0xffff0000, v245
    v_and_b32 v240, 0xffff0000, v216
    v_and_b32 v241, 0xffff0000, v217
    v_and_b32 v242, 0xffff0000, v218
    v_and_b32 v243, 0xffff0000, v219
    v_mul_f32 v236, v236, v240
    v_mul_f32 v237, v237, v241
    v_mul_f32 v238, v238, v242
    v_mul_f32 v239, v239, v243
    v_cvt_pk_bf16_f32 v246, v239, v238
    v_cvt_pk_bf16_f32 v247, v237, v236
    ds_write_b64 v42, v[246:247] offset:136
    s_waitcnt vmcnt(4) lgkmcnt(0)
    s_barrier
    ds_read_b64 v[208:209], v43
    ds_read_b64 v[210:211], v43 offset:8
    s_waitcnt lgkmcnt(0)
    buffer_store_dwordx4 v[208:211], v37, s[28:31], s77 offen sc1
    s_nop 1
    ds_read2_b32 v[208:209], v44 offset0:0 offset1:32
    ds_read2_b32 v[210:211], v44 offset0:64 offset1:96
    ds_read2_b32 v[212:213], v44 offset0:128 offset1:160
    ds_read2_b32 v[214:215], v44 offset0:192 offset1:224
    ds_read2_b32 v[216:217], v45 offset0:0 offset1:32
    ds_read2_b32 v[218:219], v45 offset0:64 offset1:96
    ds_read_b64_tr_b16 v[60:61], v25 offset:0
    ds_read_b64_tr_b16 v[62:63], v25 offset:2048
    ds_read_b64_tr_b16 v[64:65], v25 offset:8192
    ds_read_b64_tr_b16 v[66:67], v25 offset:10240
    ds_read_b64_tr_b16 v[68:69], v25 offset:16384
    ds_read_b64_tr_b16 v[70:71], v25 offset:18432
    ds_read_b64_tr_b16 v[72:73], v25 offset:24576
    ds_read_b64_tr_b16 v[74:75], v25 offset:26624
    ds_read_b64_tr_b16 v[76:77], v26 offset:0
    ds_read_b64_tr_b16 v[78:79], v26 offset:2048
    s_add_u32 s48, s3, 0
    s_mul_i32 s49, s48, 52
    s_lshr_b32 s49, s49, 8
    s_mul_i32 s50, s49, 5
    s_sub_u32 s50, s48, s50
    s_mul_i32 s49, s49, 54
    s_add_u32 s49, s49, s76
    s_add_u32 s49, s49, 0
    s_mul_i32 s49, s49, 5
    s_add_u32 s49, s49, s50
    s_lshl_b32 s49, s49, 10
    s_add_u32 s49, s49, 14680064
    s_waitcnt lgkmcnt(8)
    buffer_store_dwordx4 v[60:63], v31, s[28:31], s49 offen sc1
    s_add_u32 s48, s3, 8
    s_nop 0
    s_mul_i32 s49, s48, 52
    s_lshr_b32 s49, s49, 8
    s_mul_i32 s50, s49, 5
    s_sub_u32 s50, s48, s50
    s_mul_i32 s49, s49, 54
    s_add_u32 s49, s49, s76
    s_add_u32 s49, s49, 0
    s_mul_i32 s49, s49, 5
    s_add_u32 s49, s49, s50
    s_lshl_b32 s49, s49, 10
    s_add_u32 s49, s49, 14680064
    s_waitcnt lgkmcnt(6)
    buffer_store_dwordx4 v[64:67], v31, s[28:31], s49 offen sc1
    s_add_u32 s48, s3, 16
    s_nop 0
    s_mul_i32 s49, s48, 52
    s_lshr_b32 s49, s49, 8
    s_mul_i32 s50, s49, 5
    s_sub_u32 s50, s48, s50
    s_mul_i32 s49, s49, 54
    s_add_u32 s49, s49, s76
    s_add_u32 s49, s49, 0
    s_mul_i32 s49, s49, 5
    s_add_u32 s49, s49, s50
    s_lshl_b32 s49, s49, 10
    s_add_u32 s49, s49, 14680064
    s_waitcnt lgkmcnt(4)
    buffer_store_dwordx4 v[68:71], v31, s[28:31], s49 offen sc1
    s_add_u32 s48, s3, 24
    s_nop 0
    s_mul_i32 s49, s48, 52
    s_lshr_b32 s49, s49, 8
    s_mul_i32 s50, s49, 5
    s_sub_u32 s50, s48, s50
    s_mul_i32 s49, s49, 54
    s_add_u32 s49, s49, s76
    s_add_u32 s49, s49, 0
    s_mul_i32 s49, s49, 5
    s_add_u32 s49, s49, s50
    s_lshl_b32 s49, s49, 10
    s_add_u32 s49, s49, 14680064
    s_waitcnt lgkmcnt(2)
    buffer_store_dwordx4 v[72:75], v31, s[28:31], s49 offen sc1
    s_add_u32 s48, s3, 32
    s_nop 0
    s_mul_i32 s49, s48, 52
    s_lshr_b32 s49, s49, 8
    s_mul_i32 s50, s49, 5
    s_sub_u32 s50, s48, s50
    s_mul_i32 s49, s49, 54
    s_add_u32 s49, s49, s76
    s_add_u32 s49, s49, 0
    s_mul_i32 s49, s49, 5
    s_add_u32 s49, s49, s50
    s_lshl_b32 s49, s49, 10
    s_add_u32 s49, s49, 14680064
    s_waitcnt lgkmcnt(0)
    buffer_store_dwordx4 v[76:79], v31, s[28:31], s49 offen sc1
    s_cmp_ge_u32 s76, 22
    s_cbranch_scc1 K1_NOW2B
    ds_read_b64_tr_b16 v[60:61], v26 offset:8192
    ds_read_b64_tr_b16 v[62:63], v26 offset:10240
    ds_read_b64_tr_b16 v[64:65], v26 offset:16384
    ds_read_b64_tr_b16 v[66:67], v26 offset:18432
    ds_read_b64_tr_b16 v[68:69], v26 offset:24576
    ds_read_b64_tr_b16 v[70:71], v26 offset:26624
    ds_read_b64_tr_b16 v[72:73], v27 offset:0
    ds_read_b64_tr_b16 v[74:75], v27 offset:2048
    ds_read_b64_tr_b16 v[76:77], v27 offset:8192
    ds_read_b64_tr_b16 v[78:79], v27 offset:10240
    s_add_u32 s48, s3, 0
    s_mul_i32 s49, s48, 52
    s_lshr_b32 s49, s49, 8
    s_mul_i32 s50, s49, 5
    s_sub_u32 s50, s48, s50
    s_mul_i32 s49, s49, 54
    s_add_u32 s49, s49, s76
    s_add_u32 s49, s49, 32
    s_mul_i32 s49, s49, 5
    s_add_u32 s49, s49, s50
    s_lshl_b32 s49, s49, 10
    s_add_u32 s49, s49, 14680064
    s_waitcnt lgkmcnt(8)
    buffer_store_dwordx4 v[60:63], v31, s[28:31], s49 offen sc1
    s_add_u32 s48, s3, 8
    s_nop 0
    s_mul_i32 s49, s48, 52
    s_lshr_b32 s49, s49, 8
    s_mul_i32 s50, s49, 5
    s_sub_u32 s50, s48, s50
    s_mul_i32 s49, s49, 54
    s_add_u32 s49, s49, s76
    s_add_u32 s49, s49, 32
    s_mul_i32 s49, s49, 5
    s_add_u32 s49, s49, s50
    s_lshl_b32 s49, s49, 10
    s_add_u32 s49, s49, 14680064
    s_waitcnt lgkmcnt(6)
    buffer_store_dwordx4 v[64:67], v31, s[28:31], s49 offen sc1
    s_add_u32 s48, s3, 16
    s_nop 0
    s_mul_i32 s49, s48, 52
    s_lshr_b32 s49, s49, 8
    s_mul_i32 s50, s49, 5
    s_sub_u32 s50, s48, s50
    s_mul_i32 s49, s49, 54
    s_add_u32 s49, s49, s76
    s_add_u32 s49, s49, 32
    s_mul_i32 s49, s49, 5
    s_add_u32 s49, s49, s50
    s_lshl_b32 s49, s49, 10
    s_add_u32 s49, s49, 14680064
    s_waitcnt lgkmcnt(4)
    buffer_store_dwordx4 v[68:71], v31, s[28:31], s49 offen sc1
    s_add_u32 s48, s3, 24
    s_nop 0
    s_mul_i32 s49, s48, 52
    s_lshr_b32 s49, s49, 8
    s_mul_i32 s50, s49, 5
    s_sub_u32 s50, s48, s50
    s_mul_i32 s49, s49, 54
    s_add_u32 s49, s49, s76
    s_add_u32 s49, s49, 32
    s_mul_i32 s49, s49, 5
    s_add_u32 s49, s49, s50
    s_lshl_b32 s49, s49, 10
    s_add_u32 s49, s49, 14680064
    s_waitcnt lgkmcnt(2)
    buffer_store_dwordx4 v[72:75], v31, s[28:31], s49 offen sc1
    s_add_u32 s48, s3, 32
    s_nop 0
    s_mul_i32 s49, s48, 52
    s_lshr_b32 s49, s49, 8
    s_mul_i32 s50, s49, 5
    s_sub_u32 s50, s48, s50
    s_mul_i32 s49, s49, 54
    s_add_u32 s49, s49, s76
    s_add_u32 s49, s49, 32
    s_mul_i32 s49, s49, 5
    s_add_u32 s49, s49, s50
    s_lshl_b32 s49, s49, 10
    s_add_u32 s49, s49, 14680064
    s_waitcnt lgkmcnt(0)
    buffer_store_dwordx4 v[76:79], v31, s[28:31], s49 offen sc1
K1_NOW2B:
    s_waitcnt lgkmcnt(0)
    v_lshlrev_b32 v224, 16, v208
    v_lshlrev_b32 v225, 16, v209
    v_lshlrev_b32 v226, 16, v210
    v_lshlrev_b32 v227, 16, v211
    v_lshlrev_b32 v228, 16, v212
    v_lshlrev_b32 v229, 16, v213
    v_lshlrev_b32 v230, 16, v214
    v_lshlrev_b32 v231, 16, v104
    v_and_b32 v232, 0xffff0000, v104
    v_lshlrev_b32 v233, 16, v105
    v_and_b32 v234, 0xffff0000, v105
    v_mul_f32 v236, v224, v234
    v_mul_f32 v237, v225, v234
    v_mul_f32 v238, v226, v234
    v_mul_f32 v239, v227, v234
    v_cvt_pk_bf16_f32 v244, v236, v237
    v_lshlrev_b32 v236, 16, v244
    v_and_b32 v237, 0xffff0000, v244
    v_cvt_pk_bf16_f32 v245, v238, v239
    v_lshlrev_b32 v238, 16, v245
    v_and_b32 v239, 0xffff0000, v245
    v_mul_f32 v240, v225, v233
    v_mul_f32 v241, v226, v233
    v_mul_f32 v242, v227, v233
    v_mul_f32 v243, v228, v233
    v_cvt_pk_bf16_f32 v244, v240, v241
    v_lshlrev_b32 v240, 16, v244
    v_and_b32 v241, 0xffff0000, v244
    v_cvt_pk_bf16_f32 v245, v242, v243
    v_lshlrev_b32 v242, 16, v245
    v_and_b32 v243, 0xffff0000, v245
    v_add_f32 v236, v236, v240
    v_add_f32 v237, v237, v241
    v_add_f32 v238, v238, v242
    v_add_f32 v239, v239, v243
    v_cvt_pk_bf16_f32 v244, v236, v237
    v_lshlrev_b32 v236, 16, v244
    v_and_b32 v237, 0xffff0000, v244
    v_cvt_pk_bf16_f32 v245, v238, v239
    v_lshlrev_b32 v238, 16, v245
    v_and_b32 v239, 0xffff0000, v245
    v_mul_f32 v240, v226, v232
    v_mul_f32 v241, v227, v232
    v_mul_f32 v242, v228, v232
    v_mul_f32 v243, v229, v232
    v_cvt_pk_bf16_f32 v244, v240, v241
    v_lshlrev_b32 v240, 16, v244
    v_and_b32 v241, 0xffff0000, v244
    v_cvt_pk_bf16_f32 v245, v242, v243
    v_lshlrev_b32 v242, 16, v245
    v_and_b32 v243, 0xffff0000, v245
    v_add_f32 v236, v236, v240
    v_add_f32 v237, v237, v241
    v_add_f32 v238, v238, v242
    v_add_f32 v239, v239, v243
    v_cvt_pk_bf16_f32 v244, v236, v237
    v_lshlrev_b32 v236, 16, v244
    v_and_b32 v237, 0xffff0000, v244
    v_cvt_pk_bf16_f32 v245, v238, v239
    v_lshlrev_b32 v238, 16, v245
    v_and_b32 v239, 0xffff0000, v245
    v_mul_f32 v240, v227, v231
    v_mul_f32 v241, v228, v231
    v_mul_f32 v242, v229, v231
    v_mul_f32 v243, v230, v231
    v_cvt_pk_bf16_f32 v244, v240, v241
    v_lshlrev_b32 v240, 16, v244
    v_and_b32 v241, 0xffff0000, v244
    v_cvt_pk_bf16_f32 v245, v242, v243
    v_lshlrev_b32 v242, 16, v245
    v_and_b32 v243, 0xffff0000, v245
    v_add_f32 v236, v236, v240
    v_add_f32 v237, v237, v241
    v_add_f32 v238, v238, v242
    v_add_f32 v239, v239, v243
    v_cvt_pk_bf16_f32 v244, v236, v237
    v_lshlrev_b32 v236, 16, v244
    v_and_b32 v237, 0xffff0000, v244
    v_cvt_pk_bf16_f32 v245, v238, v239
    v_lshlrev_b32 v238, 16, v245
    v_and_b32 v239, 0xffff0000, v245
    v_lshlrev_b32 v240, 16, v216
    v_lshlrev_b32 v241, 16, v217
    v_lshlrev_b32 v242, 16, v218
    v_lshlrev_b32 v243, 16, v219
    v_mul_f32 v236, v236, v240
    v_mul_f32 v237, v237, v241
    v_mul_f32 v238, v238, v242
    v_mul_f32 v239, v239, v243
    v_cvt_pk_bf16_f32 v246, v239, v238
    v_cvt_pk_bf16_f32 v247, v237, v236
    ds_write_b64 v46, v[246:247] offset:0
    v_and_b32 v224, 0xffff0000, v208
    v_and_b32 v225, 0xffff0000, v209
    v_and_b32 v226, 0xffff0000, v210
    v_and_b32 v227, 0xffff0000, v211
    v_and_b32 v228, 0xffff0000, v212
    v_and_b32 v229, 0xffff0000, v213
    v_and_b32 v230, 0xffff0000, v214
    v_lshlrev_b32 v231, 16, v106
    v_and_b32 v232, 0xffff0000, v106
    v_lshlrev_b32 v233, 16, v107
    v_and_b32 v234, 0xffff0000, v107
    v_mul_f32 v236, v224, v234
    v_mul_f32 v237, v225, v234
    v_mul_f32 v238, v226, v234
    v_mul_f32 v239, v227, v234
    v_cvt_pk_bf16_f32 v244, v236, v237
    v_lshlrev_b32 v236, 16, v244
    v_and_b32 v237, 0xffff0000, v244
    v_cvt_pk_bf16_f32 v245, v238, v239
    v_lshlrev_b32 v238, 16, v245
    v_and_b32 v239, 0xffff0000, v245
    v_mul_f32 v240, v225, v233
    v_mul_f32 v241, v226, v233
    v_mul_f32 v242, v227, v233
    v_mul_f32 v243, v228, v233
    v_cvt_pk_bf16_f32 v244, v240, v241
    v_lshlrev_b32 v240, 16, v244
    v_and_b32 v241, 0xffff0000, v244
    v_cvt_pk_bf16_f32 v245, v242, v243
    v_lshlrev_b32 v242, 16, v245
    v_and_b32 v243, 0xffff0000, v245
    v_add_f32 v236, v236, v240
    v_add_f32 v237, v237, v241
    v_add_f32 v238, v238, v242
    v_add_f32 v239, v239, v243
    v_cvt_pk_bf16_f32 v244, v236, v237
    v_lshlrev_b32 v236, 16, v244
    v_and_b32 v237, 0xffff0000, v244
    v_cvt_pk_bf16_f32 v245, v238, v239
    v_lshlrev_b32 v238, 16, v245
    v_and_b32 v239, 0xffff0000, v245
    v_mul_f32 v240, v226, v232
    v_mul_f32 v241, v227, v232
    v_mul_f32 v242, v228, v232
    v_mul_f32 v243, v229, v232
    v_cvt_pk_bf16_f32 v244, v240, v241
    v_lshlrev_b32 v240, 16, v244
    v_and_b32 v241, 0xffff0000, v244
    v_cvt_pk_bf16_f32 v245, v242, v243
    v_lshlrev_b32 v242, 16, v245
    v_and_b32 v243, 0xffff0000, v245
    v_add_f32 v236, v236, v240
    v_add_f32 v237, v237, v241
    v_add_f32 v238, v238, v242
    v_add_f32 v239, v239, v243
    v_cvt_pk_bf16_f32 v244, v236, v237
    v_lshlrev_b32 v236, 16, v244
    v_and_b32 v237, 0xffff0000, v244
    v_cvt_pk_bf16_f32 v245, v238, v239
    v_lshlrev_b32 v238, 16, v245
    v_and_b32 v239, 0xffff0000, v245
    v_mul_f32 v240, v227, v231
    v_mul_f32 v241, v228, v231
    v_mul_f32 v242, v229, v231
    v_mul_f32 v243, v230, v231
    v_cvt_pk_bf16_f32 v244, v240, v241
    v_lshlrev_b32 v240, 16, v244
    v_and_b32 v241, 0xffff0000, v244
    v_cvt_pk_bf16_f32 v245, v242, v243
    v_lshlrev_b32 v242, 16, v245
    v_and_b32 v243, 0xffff0000, v245
    v_add_f32 v236, v236, v240
    v_add_f32 v237, v237, v241
    v_add_f32 v238, v238, v242
    v_add_f32 v239, v239, v243
    v_cvt_pk_bf16_f32 v244, v236, v237
    v_lshlrev_b32 v236, 16, v244
    v_and_b32 v237, 0xffff0000, v244
    v_cvt_pk_bf16_f32 v245, v238, v239
    v_lshlrev_b32 v238, 16, v245
    v_and_b32 v239, 0xffff0000, v245
    v_and_b32 v240, 0xffff0000, v216
    v_and_b32 v241, 0xffff0000, v217
    v_and_b32 v242, 0xffff0000, v218
    v_and_b32 v243, 0xffff0000, v219
    v_mul_f32 v236, v236, v240
    v_mul_f32 v237, v237, v241
    v_mul_f32 v238, v238, v242
    v_mul_f32 v239, v239, v243
    v_cvt_pk_bf16_f32 v246, v239, v238
    v_cvt_pk_bf16_f32 v247, v237, v236
    ds_write_b64 v46, v[246:247] offset:136
    s_waitcnt vmcnt(6) lgkmcnt(0)
    s_barrier
    ds_read_b64 v[208:209], v47
    ds_read_b64 v[210:211], v47 offset:8
    s_waitcnt lgkmcnt(0)
    buffer_store_dwordx4 v[208:211], v37, s[28:31], s78 offen sc1
    s_nop 1
    ds_read2_b32 v[208:209], v48 offset0:0 offset1:32
    ds_read2_b32 v[210:211], v48 offset0:64 offset1:96
    ds_read2_b32 v[212:213], v48 offset0:128 offset1:160
    ds_read2_b32 v[214:215], v48 offset0:192 offset1:224
    ds_read2_b32 v[216:217], v49 offset0:0 offset1:32
    ds_read2_b32 v[218:219], v49 offset0:64 offset1:96
    s_waitcnt lgkmcnt(0)
    v_lshlrev_b32 v224, 16, v208
    v_lshlrev_b32 v225, 16, v209
    v_lshlrev_b32 v226, 16, v210
    v_lshlrev_b32 v227, 16, v211
    v_lshlrev_b32 v228, 16, v212
    v_lshlrev_b32 v229, 16, v213
    v_lshlrev_b32 v230, 16, v214
    v_lshlrev_b32 v231, 16, v108
    v_and_b32 v232, 0xffff0000, v108
    v_lshlrev_b32 v233, 16, v109
    v_and_b32 v234, 0xffff0000, v109
    v_mul_f32 v236, v224, v234
    v_mul_f32 v237, v225, v234
    v_mul_f32 v238, v226, v234
    v_mul_f32 v239, v227, v234
    v_cvt_pk_bf16_f32 v244, v236, v237
    v_lshlrev_b32 v236, 16, v244
    v_and_b32 v237, 0xffff0000, v244
    v_cvt_pk_bf16_f32 v245, v238, v239
    v_lshlrev_b32 v238, 16, v245
    v_and_b32 v239, 0xffff0000, v245
    v_mul_f32 v240, v225, v233
    v_mul_f32 v241, v226, v233
    v_mul_f32 v242, v227, v233
    v_mul_f32 v243, v228, v233
    v_cvt_pk_bf16_f32 v244, v240, v241
    v_lshlrev_b32 v240, 16, v244
    v_and_b32 v241, 0xffff0000, v244
    v_cvt_pk_bf16_f32 v245, v242, v243
    v_lshlrev_b32 v242, 16, v245
    v_and_b32 v243, 0xffff0000, v245
    v_add_f32 v236, v236, v240
    v_add_f32 v237, v237, v241
    v_add_f32 v238, v238, v242
    v_add_f32 v239, v239, v243
    v_cvt_pk_bf16_f32 v244, v236, v237
    v_lshlrev_b32 v236, 16, v244
    v_and_b32 v237, 0xffff0000, v244
    v_cvt_pk_bf16_f32 v245, v238, v239
    v_lshlrev_b32 v238, 16, v245
    v_and_b32 v239, 0xffff0000, v245
    v_mul_f32 v240, v226, v232
    v_mul_f32 v241, v227, v232
    v_mul_f32 v242, v228, v232
    v_mul_f32 v243, v229, v232
    v_cvt_pk_bf16_f32 v244, v240, v241
    v_lshlrev_b32 v240, 16, v244
    v_and_b32 v241, 0xffff0000, v244
    v_cvt_pk_bf16_f32 v245, v242, v243
    v_lshlrev_b32 v242, 16, v245
    v_and_b32 v243, 0xffff0000, v245
    v_add_f32 v236, v236, v240
    v_add_f32 v237, v237, v241
    v_add_f32 v238, v238, v242
    v_add_f32 v239, v239, v243
    v_cvt_pk_bf16_f32 v244, v236, v237
    v_lshlrev_b32 v236, 16, v244
    v_and_b32 v237, 0xffff0000, v244
    v_cvt_pk_bf16_f32 v245, v238, v239
    v_lshlrev_b32 v238, 16, v245
    v_and_b32 v239, 0xffff0000, v245
    v_mul_f32 v240, v227, v231
    v_mul_f32 v241, v228, v231
    v_mul_f32 v242, v229, v231
    v_mul_f32 v243, v230, v231
    v_cvt_pk_bf16_f32 v244, v240, v241
    v_lshlrev_b32 v240, 16, v244
    v_and_b32 v241, 0xffff0000, v244
    v_cvt_pk_bf16_f32 v245, v242, v243
    v_lshlrev_b32 v242, 16, v245
    v_and_b32 v243, 0xffff0000, v245
    v_add_f32 v236, v236, v240
    v_add_f32 v237, v237, v241
    v_add_f32 v238, v238, v242
    v_add_f32 v239, v239, v243
    v_cvt_pk_bf16_f32 v244, v236, v237
    v_lshlrev_b32 v236, 16, v244
    v_and_b32 v237, 0xffff0000, v244
    v_cvt_pk_bf16_f32 v245, v238, v239
    v_lshlrev_b32 v238, 16, v245
    v_and_b32 v239, 0xffff0000, v245
    v_lshlrev_b32 v240, 16, v216
    v_lshlrev_b32 v241, 16, v217
    v_lshlrev_b32 v242, 16, v218
    v_lshlrev_b32 v243, 16, v219
    v_mul_f32 v236, v236, v240
    v_mul_f32 v237, v237, v241
    v_mul_f32 v238, v238, v242
    v_mul_f32 v239, v239, v243
    v_cvt_pk_bf16_f32 v246, v239, v238
    v_cvt_pk_bf16_f32 v247, v237, v236
    ds_write_b64 v50, v[246:247] offset:0
    v_and_b32 v224, 0xffff0000, v208
    v_and_b32 v225, 0xffff0000, v209
    v_and_b32 v226, 0xffff0000, v210
    v_and_b32 v227, 0xffff0000, v211
    v_and_b32 v228, 0xffff0000, v212
    v_and_b32 v229, 0xffff0000, v213
    v_and_b32 v230, 0xffff0000, v214
    v_lshlrev_b32 v231, 16, v110
    v_and_b32 v232, 0xffff0000, v110
    v_lshlrev_b32 v233, 16, v111
    v_and_b32 v234, 0xffff0000, v111
    v_mul_f32 v236, v224, v234
    v_mul_f32 v237, v225, v234
    v_mul_f32 v238, v226, v234
    v_mul_f32 v239, v227, v234
    v_cvt_pk_bf16_f32 v244, v236, v237
    v_lshlrev_b32 v236, 16, v244
    v_and_b32 v237, 0xffff0000, v244
    v_cvt_pk_bf16_f32 v245, v238, v239
    v_lshlrev_b32 v238, 16, v245
    v_and_b32 v239, 0xffff0000, v245
    v_mul_f32 v240, v225, v233
    v_mul_f32 v241, v226, v233
    v_mul_f32 v242, v227, v233
    v_mul_f32 v243, v228, v233
    v_cvt_pk_bf16_f32 v244, v240, v241
    v_lshlrev_b32 v240, 16, v244
    v_and_b32 v241, 0xffff0000, v244
    v_cvt_pk_bf16_f32 v245, v242, v243
    v_lshlrev_b32 v242, 16, v245
    v_and_b32 v243, 0xffff0000, v245
    v_add_f32 v236, v236, v240
    v_add_f32 v237, v237, v241
    v_add_f32 v238, v238, v242
    v_add_f32 v239, v239, v243
    v_cvt_pk_bf16_f32 v244, v236, v237
    v_lshlrev_b32 v236, 16, v244
    v_and_b32 v237, 0xffff0000, v244
    v_cvt_pk_bf16_f32 v245, v238, v239
    v_lshlrev_b32 v238, 16, v245
    v_and_b32 v239, 0xffff0000, v245
    v_mul_f32 v240, v226, v232
    v_mul_f32 v241, v227, v232
    v_mul_f32 v242, v228, v232
    v_mul_f32 v243, v229, v232
    v_cvt_pk_bf16_f32 v244, v240, v241
    v_lshlrev_b32 v240, 16, v244
    v_and_b32 v241, 0xffff0000, v244
    v_cvt_pk_bf16_f32 v245, v242, v243
    v_lshlrev_b32 v242, 16, v245
    v_and_b32 v243, 0xffff0000, v245
    v_add_f32 v236, v236, v240
    v_add_f32 v237, v237, v241
    v_add_f32 v238, v238, v242
    v_add_f32 v239, v239, v243
    v_cvt_pk_bf16_f32 v244, v236, v237
    v_lshlrev_b32 v236, 16, v244
    v_and_b32 v237, 0xffff0000, v244
    v_cvt_pk_bf16_f32 v245, v238, v239
    v_lshlrev_b32 v238, 16, v245
    v_and_b32 v239, 0xffff0000, v245
    v_mul_f32 v240, v227, v231
    v_mul_f32 v241, v228, v231
    v_mul_f32 v242, v229, v231
    v_mul_f32 v243, v230, v231
    v_cvt_pk_bf16_f32 v244, v240, v241
    v_lshlrev_b32 v240, 16, v244
    v_and_b32 v241, 0xffff0000, v244
    v_cvt_pk_bf16_f32 v245, v242, v243
    v_lshlrev_b32 v242, 16, v245
    v_and_b32 v243, 0xffff0000, v245
    v_add_f32 v236, v236, v240
    v_add_f32 v237, v237, v241
    v_add_f32 v238, v238, v242
    v_add_f32 v239, v239, v243
    v_cvt_pk_bf16_f32 v244, v236, v237
    v_lshlrev_b32 v236, 16, v244
    v_and_b32 v237, 0xffff0000, v244
    v_cvt_pk_bf16_f32 v245, v238, v239
    v_lshlrev_b32 v238, 16, v245
    v_and_b32 v239, 0xffff0000, v245
    v_and_b32 v240, 0xffff0000, v216
    v_and_b32 v241, 0xffff0000, v217
    v_and_b32 v242, 0xffff0000, v218
    v_and_b32 v243, 0xffff0000, v219
    v_mul_f32 v236, v236, v240
    v_mul_f32 v237, v237, v241
    v_mul_f32 v238, v238, v242
    v_mul_f32 v239, v239, v243
    v_cvt_pk_bf16_f32 v246, v239, v238
    v_cvt_pk_bf16_f32 v247, v237, v236
    ds_write_b64 v50, v[246:247] offset:136
    s_waitcnt lgkmcnt(0)
    s_barrier
    ds_read_b64 v[208:209], v51
    ds_read_b64 v[210:211], v51 offset:8
    s_waitcnt lgkmcnt(0)
    buffer_store_dwordx4 v[208:211], v37, s[28:31], s79 offen sc1
    v_mov_b32 v248, 0
    buffer_load_dword v249, v248, s[96:99], 0 offen sc1
    s_waitcnt vmcnt(0) lgkmcnt(0)
    s_barrier
    s_cmp_lg_u32 s3, 7
    s_cbranch_scc1 F_AI5
    s_mov_b32 s94, 0
F_AIW5:
    v_readfirstlane_b32 s48, v249
    s_cmp_eq_u32 s48, 1
    s_cbranch_scc1 F_AIG5
    s_sleep 8
    v_mov_b32 v248, 0
    buffer_load_dword v249, v248, s[96:99], 0 offen sc1
    s_waitcnt vmcnt(0)
    s_add_u32 s94, s94, 1
    s_cmp_lt_u32 s94, 0x100000
    s_cbranch_scc1 F_AIW5
F_AIG5:
    s_lshl_b32 s48, s4, 8
    s_add_u32 s48, s48, 16973824
    v_mov_b32 v248, s48
    v_mov_b32 v249, 1
    s_mov_b64 exec, 1
    buffer_atomic_add v249, v248, s[28:31], 0 offen sc0 sc1
    s_mov_b64 exec, -1
F_AI5:
    s_cmp_lg_u32 s3, 7
    s_cbranch_scc1 F_AC6
    s_waitcnt vmcnt(0)
    v_readfirstlane_b32 s62, v249
    s_cmp_lg_u32 s62, 31
    s_cbranch_scc1 F_AC6
    v_lshlrev_b32 v248, 7, v2
    s_lshl_b32 s62, s4, 2
    s_add_u32 s62, s62, 16990208
    v_add_u32 v248, s62, v248
    v_mov_b32 v249, 1
    s_movk_i32 s62, 0x2000
    s_movk_i32 s63, 0x4000
    buffer_store_dword v249, v248, s[28:31], 0 offen sc1
    buffer_store_dword v249, v248, s[28:31], s62 offen sc1
    buffer_store_dword v249, v248, s[28:31], s63 offen sc1
    s_movk_i32 s62, 0x6000
    s_nop 0
    buffer_store_dword v249, v248, s[28:31], s62 offen sc1
F_AC6:
    s_cmp_lt_i32 s100, 0
    s_cbranch_scc1 F_CL7
    s_mov_b32 s16, s68
    s_and_b32 s17, s69, 0xffff
    s_mov_b32 s18, 2621440
    s_mov_b32 s19, 0x00020000
    s_lshl_b32 s101, s100, 12
    v_lshlrev_b32 v39, 4, v2
    buffer_load_dwordx4 v[180:183], v39, s[16:19], s101 offen offset:0
    buffer_load_dwordx4 v[184:187], v39, s[16:19], s101 offen offset:4
    buffer_load_dwordx4 v[188:191], v39, s[16:19], s101 offen offset:8
    buffer_load_dwordx4 v[192:195], v39, s[16:19], s101 offen offset:1024
    buffer_load_dwordx4 v[196:199], v39, s[16:19], s101 offen offset:1028
    buffer_load_dwordx4 v[200:203], v39, s[16:19], s101 offen offset:1032
    buffer_load_dwordx4 v[204:207], v39, s[16:19], s101 offen offset:2048
    buffer_load_dwordx4 v[208:211], v39, s[16:19], s101 offen offset:2052
    buffer_load_dwordx4 v[212:215], v39, s[16:19], s101 offen offset:2056
    buffer_load_dwordx4 v[216:219], v39, s[16:19], s101 offen offset:3072
    buffer_load_dwordx4 v[220:223], v39, s[16:19], s101 offen offset:3076
    buffer_load_dwordx4 v[224:227], v39, s[16:19], s101 offen offset:3080
F_CL7:
    s_mov_b32 s35, 0
F_PH2:
    s_lshl_b32 s34, s4, 2
    s_lshr_b32 s48, s5, 3
    s_add_u32 s34, s34, s48
    s_and_b32 s36, s5, 7
    s_cmp_eq_u32 s3, 7
    s_cbranch_scc1 F_HELP
    s_cmp_ge_u32 s3, 4
    s_cbranch_scc1 F_CONV
    s_mov_b32 s12, s72
    s_and_b32 s13, s73, 0xffff
    s_mov_b32 s14, 2621440
    s_mov_b32 s15, 0x00020000
    v_lshlrev_b32 v3, 4, v2
    v_add_u32 v8, 0x1000, v3
    s_add_u32 s48, s3, 0
    s_and_b32 s48, s48, 3
    s_lshl_b32 s48, s48, 10
    v_add_u32 v4, s48, v3
    s_add_u32 s48, s3, 1
    s_and_b32 s48, s48, 3
    s_lshl_b32 s48, s48, 10
    v_add_u32 v5, s48, v3
    s_add_u32 s48, s3, 2
    s_and_b32 s48, s48, 3
    s_lshl_b32 s48, s48, 10
    v_add_u32 v6, s48, v3
    s_add_u32 s48, s3, 3
    s_and_b32 s48, s48, 3
    s_lshl_b32 s48, s48, 10
    v_add_u32 v7, s48, v3
    s_mul_i32 s50, s34, 54
    s_add_u32 s50, s50, s3
    s_lshl_b32 s50, s50, 12
    s_mul_i32 s51, s36, 54
    s_add_u32 s51, s51, s3
    s_mul_i32 s51, s51, 5120
    s_add_u32 s51, s51, 14680064
    s_cmp_ge_u32 s3, 2
    s_cselect_b32 s52, 0x40000000, 0
    v_and_b32 v9, 15, v2
    v_lshrrev_b32 v10, 4, v2
    v_mov_b32 v15, 0x80000000
    s_lshl_b32 s53, s34, 6
    s_lshl_b32 s48, s3, 4
    s_add_u32 s53, s53, s48
    s_mul_i32 s54, s53, 1280
    s_mul_i32 s48, s36, 160
    s_add_u32 s54, s54, s48
    s_mul_i32 s55, s3, 3072
    s_add_u32 s55, s55, 63744
    v_add_u32 v11, 0, v2
    v_mul_u32_u24 v12, 6554, v11
    v_lshrrev_b32 v12, 16, v12
    v_mul_u32_u24 v13, 10, v12
    v_sub_u32 v13, v11, v13
    v_mul_u32_u24 v12, 1280, v12
    v_lshl_add_u32 v240, v13, 4, v12
    v_add_u32 v11, 64, v2
    v_mul_u32_u24 v12, 6554, v11
    v_lshrrev_b32 v12, 16, v12
    v_mul_u32_u24 v13, 10, v12
    v_sub_u32 v13, v11, v13
    v_mul_u32_u24 v12, 1280, v12
    v_lshl_add_u32 v241, v13, 4, v12
    v_add_u32 v11, 128, v2
    v_mul_u32_u24 v12, 6554, v11
    v_lshrrev_b32 v12, 16, v12
    v_mul_u32_u24 v13, 10, v12
    v_sub_u32 v13, v11, v13
    v_mul_u32_u24 v12, 1280, v12
    v_lshl_add_u32 v242, v13, 4, v12
    v_cmp_gt_u32 vcc, 32, v2
    s_nop 1
    v_cndmask_b32 v242, v15, v242, vcc
    s_add_u32 m0, s55, 0
    s_nop 0
    buffer_load_dwordx4 v240, s[8:11], s54 offen lds
    s_add_u32 m0, s55, 1024
    s_nop 0
    buffer_load_dwordx4 v241, s[8:11], s54 offen lds
    s_add_u32 m0, s55, 2048
    s_nop 0
    buffer_load_dwordx4 v242, s[8:11], s54 offen lds
    v_mov_b32 v16, 0
    v_mov_b32 v17, 0
    v_mov_b32 v18, 0
    v_mov_b32 v19, 0
    v_mov_b32 v20, 0
    v_mov_b32 v21, 0
    v_mov_b32 v22, 0
    v_mov_b32 v23, 0
    v_mov_b32 v24, 0
    v_mov_b32 v25, 0
    v_mov_b32 v26, 0
    v_mov_b32 v27, 0
    v_mov_b32 v28, 0
    v_mov_b32 v29, 0
    v_mov_b32 v30, 0
    v_mov_b32 v31, 0
    v_mov_b32 v32, 0
    v_mov_b32 v33, 0
    v_mov_b32 v34, 0
    v_mov_b32 v35, 0
    v_mov_b32 v36, 0
    v_mov_b32 v37, 0
    v_mov_b32 v38, 0
    v_mov_b32 v39, 0
    v_mov_b32 v40, 0
    v_mov_b32 v41, 0
    v_mov_b32 v42, 0
    v_mov_b32 v43, 0
    v_mov_b32 v44, 0
    v_mov_b32 v45, 0
    v_mov_b32 v46, 0
    v_mov_b32 v47, 0
    v_mov_b32 v48, 0
    v_mov_b32 v49, 0
    v_mov_b32 v50, 0
    v_mov_b32 v51, 0
    v_mov_b32 v52, 0
    v_mov_b32 v53, 0
    v_mov_b32 v54, 0
    v_mov_b32 v55, 0
    v_mov_b32 v56, 0
    v_mov_b32 v57, 0
    v_mov_b32 v58, 0
    v_mov_b32 v59, 0
    v_mov_b32 v60, 0
    v_mov_b32 v61, 0
    v_mov_b32 v62, 0
    v_mov_b32 v63, 0
    v_mov_b32 v64, 0
    v_mov_b32 v65, 0
    v_mov_b32 v66, 0
    v_mov_b32 v67, 0
    v_mov_b32 v68, 0
    v_mov_b32 v69, 0
    v_mov_b32 v70, 0
    v_mov_b32 v71, 0
    v_mov_b32 v72, 0
    v_mov_b32 v73, 0
    v_mov_b32 v74, 0
    v_mov_b32 v75, 0
    v_mov_b32 v76, 0
    v_mov_b32 v77, 0
    v_mov_b32 v78, 0
    v_mov_b32 v79, 0
    v_mov_b32 v80, 0
    v_mov_b32 v81, 0
    v_mov_b32 v82, 0
    v_mov_b32 v83, 0
    v_mov_b32 v84, 0
    v_mov_b32 v85, 0
    v_mov_b32 v86, 0
    v_mov_b32 v87, 0
    v_mov_b32 v88, 0
    v_mov_b32 v89, 0
    v_mov_b32 v90, 0
    v_mov_b32 v91, 0
    v_mov_b32 v92, 0
    v_mov_b32 v93, 0
    v_mov_b32 v94, 0
    v_mov_b32 v95, 0
    v_add_u32 v14, s53, v9
    v_lshlrev_b32 v14, 3, v14
    v_add_u32 v14, 13631488, v14
    v_mov_b32 v13, 160256
    s_mul_i32 s62, s5, 0
    s_mul_i32 s48, s62, 147
    s_lshr_b32 s48, s48, 11
    s_mul_i32 s48, s48, 14
    s_sub_u32 s62, s62, s48
    s_mov_b32 s63, s62
    ds_read_b32 v11, v13 offset:8
    s_waitcnt lgkmcnt(0)
    v_readfirstlane_b32 s57, v11
    s_cmp_ge_u32 s5, 28
    s_cselect_b32 s57, 2, s57
    s_cmp_lg_u32 s57, 0
    s_cbranch_scc1 F_G2A
    v_mov_b32 v96, 160256
    v_mov_b32 v97, 1
    s_and_b32 s48, s6, 1
    s_lshl_b32 s48, s48, 4
    v_add_u32 v99, s48, v2
    v_lshlrev_b32 v99, 3, v99
    s_lshr_b32 s48, s6, 1
    v_add_u32 v99, s48, v99
    v_lshlrev_b32 v99, 7, v99
    s_lshl_b32 s48, s7, 2
    s_add_u32 s48, s48, 16990240
    v_add_u32 v99, s48, v99
    s_waitcnt vmcnt(0)
    s_mov_b64 exec, 1
    ds_add_rtn_u32 v98, v96, v97
    s_mov_b64 exec, -1
    s_waitcnt lgkmcnt(0)
    v_readfirstlane_b32 s48, v98
    s_cmp_lg_u32 s48, 7
    s_cbranch_scc1 F_HA8
    s_mov_b32 exec_lo, 0xffff
    s_mov_b32 exec_hi, 0
    buffer_store_dword v97, v99, s[28:31], 0 offen sc1
    s_mov_b64 exec, -1
F_HA8:
F_G2A:
    s_mov_b32 s94, 0
F_SP9:
    ds_read_b32 v11, v13 offset:8
    s_waitcnt lgkmcnt(0)
    v_readfirstlane_b32 s48, v11
    s_cmp_ge_u32 s48, 1
    s_cbranch_scc1 F_SPD9
    s_sleep 1
    s_add_u32 s94, s94, 1
    s_cmp_lt_u32 s94, 0x400000
    s_cbranch_scc1 F_SP9
F_SPD9:
    s_mul_i32 s58, s62, 20480
    s_add_u32 s58, s58, s51
    s_cmp_eq_u32 s62, 13
    s_cselect_b32 s48, s52, 0
    s_add_u32 s58, s58, s48
    s_add_u32 s62, s62, 1
    s_cmp_eq_u32 s62, 14
    s_cselect_b32 s62, 0, s62
    buffer_load_dwordx4 v[112:115], v3, s[28:31], s58 offen offset:0 sc1
    buffer_load_dwordx4 v[116:119], v3, s[28:31], s58 offen offset:1024 sc1
    buffer_load_dwordx4 v[120:123], v3, s[28:31], s58 offen offset:2048 sc1
    buffer_load_dwordx4 v[124:127], v3, s[28:31], s58 offen offset:3072 sc1
    buffer_load_dwordx4 v[128:131], v8, s[28:31], s58 offen sc1
    s_mul_i32 s58, s62, 20480
    s_add_u32 s58, s58, s51
    s_cmp_eq_u32 s62, 13
    s_cselect_b32 s48, s52, 0
    s_add_u32 s58, s58, s48
    s_add_u32 s62, s62, 1
    s_cmp_eq_u32 s62, 14
    s_cselect_b32 s62, 0, s62
    buffer_load_dwordx4 v[148:151], v3, s[28:31], s58 offen offset:0 sc1
    buffer_load_dwordx4 v[152:155], v3, s[28:31], s58 offen offset:1024 sc1
    buffer_load_dwordx4 v[156:159], v3, s[28:31], s58 offen offset:2048 sc1
    buffer_load_dwordx4 v[160:163], v3, s[28:31], s58 offen offset:3072 sc1
    buffer_load_dwordx4 v[164:167], v8, s[28:31], s58 offen sc1
    s_mul_i32 s58, s62, 20480
    s_add_u32 s58, s58, s51
    s_cmp_eq_u32 s62, 13
    s_cselect_b32 s48, s52, 0
    s_add_u32 s58, s58, s48
    s_add_u32 s62, s62, 1
    s_cmp_eq_u32 s62, 14
    s_cselect_b32 s62, 0, s62
    buffer_load_dwordx4 v[184:187], v3, s[28:31], s58 offen offset:0 sc1
    buffer_load_dwordx4 v[188:191], v3, s[28:31], s58 offen offset:1024 sc1
    buffer_load_dwordx4 v[192:195], v3, s[28:31], s58 offen offset:2048 sc1
    buffer_load_dwordx4 v[196:199], v3, s[28:31], s58 offen offset:3072 sc1
    buffer_load_dwordx4 v[200:203], v8, s[28:31], s58 offen sc1
    s_mul_i32 s58, s62, 20480
    s_add_u32 s58, s58, s51
    s_cmp_eq_u32 s62, 13
    s_cselect_b32 s48, s52, 0
    s_add_u32 s58, s58, s48
    s_add_u32 s62, s62, 1
    s_cmp_eq_u32 s62, 14
    s_cselect_b32 s62, 0, s62
    buffer_load_dwordx4 v[220:223], v3, s[28:31], s58 offen offset:0 sc1
    buffer_load_dwordx4 v[224:227], v3, s[28:31], s58 offen offset:1024 sc1
    buffer_load_dwordx4 v[228:231], v3, s[28:31], s58 offen offset:2048 sc1
    buffer_load_dwordx4 v[232:235], v3, s[28:31], s58 offen offset:3072 sc1
    buffer_load_dwordx4 v[236:239], v8, s[28:31], s58 offen sc1
    s_cmp_lg_u32 s57, 1
    s_cbranch_scc1 F_G2B
    v_mov_b32 v96, 160256
    v_mov_b32 v97, 1
    s_and_b32 s48, s6, 1
    s_lshl_b32 s48, s48, 4
    v_add_u32 v99, s48, v2
    v_lshlrev_b32 v99, 3, v99
    s_lshr_b32 s48, s6, 1
    v_add_u32 v99, s48, v99
    v_lshlrev_b32 v99, 7, v99
    s_lshl_b32 s48, s7, 2
    s_add_u32 s48, s48, 16990240
    v_add_u32 v99, s48, v99
    s_waitcnt vmcnt(23)
    s_mov_b64 exec, 1
    ds_add_rtn_u32 v98, v96, v97
    s_mov_b64 exec, -1
    s_waitcnt lgkmcnt(0)
    v_readfirstlane_b32 s48, v98
    s_cmp_lg_u32 s48, 7
    s_cbranch_scc1 F_HA10
    s_mov_b32 exec_lo, 0xffff
    s_mov_b32 exec_hi, 0
    buffer_store_dword v97, v99, s[28:31], 0 offen sc1
    s_mov_b64 exec, -1
F_HA10:
F_G2B:
    s_mov_b32 s94, 0
F_SP11:
    ds_read_b32 v11, v13 offset:12
    s_waitcnt lgkmcnt(0)
    v_readfirstlane_b32 s48, v11
    s_cmp_ge_u32 s48, 1
    s_cbranch_scc1 F_SPD11
    s_sleep 1
    s_add_u32 s94, s94, 1
    s_cmp_lt_u32 s94, 0x400000
    s_cbranch_scc1 F_SP11
F_SPD11:
    s_lshl_b32 s59, s63, 14
    s_add_u32 s59, s59, s50
    s_cmp_eq_u32 s63, 13
    s_cselect_b32 s48, s52, 0
    s_add_u32 s59, s59, s48
    s_add_u32 s63, s63, 1
    s_cmp_eq_u32 s63, 14
    s_cselect_b32 s63, 0, s63
    buffer_load_dwordx4 v[96:99], v4, s[28:31], s59 offen sc1
    buffer_load_dwordx4 v[100:103], v5, s[28:31], s59 offen sc1
    buffer_load_dwordx4 v[104:107], v6, s[28:31], s59 offen sc1
    buffer_load_dwordx4 v[108:111], v7, s[28:31], s59 offen sc1
    s_lshl_b32 s59, s63, 14
    s_add_u32 s59, s59, s50
    s_cmp_eq_u32 s63, 13
    s_cselect_b32 s48, s52, 0
    s_add_u32 s59, s59, s48
    s_add_u32 s63, s63, 1
    s_cmp_eq_u32 s63, 14
    s_cselect_b32 s63, 0, s63
    buffer_load_dwordx4 v[132:135], v4, s[28:31], s59 offen sc1
    buffer_load_dwordx4 v[136:139], v5, s[28:31], s59 offen sc1
    buffer_load_dwordx4 v[140:143], v6, s[28:31], s59 offen sc1
    buffer_load_dwordx4 v[144:147], v7, s[28:31], s59 offen sc1
    s_lshl_b32 s59, s63, 14
    s_add_u32 s59, s59, s50
    s_cmp_eq_u32 s63, 13
    s_cselect_b32 s48, s52, 0
    s_add_u32 s59, s59, s48
    s_add_u32 s63, s63, 1
    s_cmp_eq_u32 s63, 14
    s_cselect_b32 s63, 0, s63
    buffer_load_dwordx4 v[168:171], v4, s[28:31], s59 offen sc1
    buffer_load_dwordx4 v[172:175], v5, s[28:31], s59 offen sc1
    buffer_load_dwordx4 v[176:179], v6, s[28:31], s59 offen sc1
    buffer_load_dwordx4 v[180:183], v7, s[28:31], s59 offen sc1
    s_lshl_b32 s59, s63, 14
    s_add_u32 s59, s59, s50
    s_cmp_eq_u32 s63, 13
    s_cselect_b32 s48, s52, 0
    s_add_u32 s59, s59, s48
    s_add_u32 s63, s63, 1
    s_cmp_eq_u32 s63, 14
    s_cselect_b32 s63, 0, s63
    buffer_load_dwordx4 v[204:207], v4, s[28:31], s59 offen sc1
    buffer_load_dwordx4 v[208:211], v5, s[28:31], s59 offen sc1
    buffer_load_dwordx4 v[212:215], v6, s[28:31], s59 offen sc1
    buffer_load_dwordx4 v[216:219], v7, s[28:31], s59 offen sc1
    buffer_load_dwordx2 v[244:245], v14, s[28:31], 0 offen sc1
    s_waitcnt vmcnt(13)
    v_mfma_f32_16x16x32_bf16 v[16:19], v[112:115], v[96:99], v[16:19]
    v_mfma_f32_16x16x32_bf16 v[36:39], v[112:115], v[100:103], v[36:39]
    v_mfma_f32_16x16x32_bf16 v[56:59], v[112:115], v[104:107], v[56:59]
    v_mfma_f32_16x16x32_bf16 v[76:79], v[112:115], v[108:111], v[76:79]
    v_mfma_f32_16x16x32_bf16 v[20:23], v[116:119], v[96:99], v[20:23]
    v_mfma_f32_16x16x32_bf16 v[40:43], v[116:119], v[100:103], v[40:43]
    v_mfma_f32_16x16x32_bf16 v[60:63], v[116:119], v[104:107], v[60:63]
    v_mfma_f32_16x16x32_bf16 v[80:83], v[116:119], v[108:111], v[80:83]
    s_mul_i32 s58, s62, 20480
    s_add_u32 s58, s58, s51
    s_cmp_eq_u32 s62, 13
    s_cselect_b32 s48, s52, 0
    s_add_u32 s58, s58, s48
    s_add_u32 s62, s62, 1
    s_cmp_eq_u32 s62, 14
    s_cselect_b32 s62, 0, s62
    buffer_load_dwordx4 v[112:115], v3, s[28:31], s58 offen offset:0 sc1
    v_mfma_f32_16x16x32_bf16 v[24:27], v[120:123], v[96:99], v[24:27]
    v_mfma_f32_16x16x32_bf16 v[44:47], v[120:123], v[100:103], v[44:47]
    v_mfma_f32_16x16x32_bf16 v[64:67], v[120:123], v[104:107], v[64:67]
    v_mfma_f32_16x16x32_bf16 v[84:87], v[120:123], v[108:111], v[84:87]
    buffer_load_dwordx4 v[116:119], v3, s[28:31], s58 offen offset:1024 sc1
    v_mfma_f32_16x16x32_bf16 v[28:31], v[124:127], v[96:99], v[28:31]
    v_mfma_f32_16x16x32_bf16 v[48:51], v[124:127], v[100:103], v[48:51]
    v_mfma_f32_16x16x32_bf16 v[68:71], v[124:127], v[104:107], v[68:71]
    v_mfma_f32_16x16x32_bf16 v[88:91], v[124:127], v[108:111], v[88:91]
    buffer_load_dwordx4 v[120:123], v3, s[28:31], s58 offen offset:2048 sc1
    v_mfma_f32_16x16x32_bf16 v[32:35], v[128:131], v[96:99], v[32:35]
    v_mfma_f32_16x16x32_bf16 v[52:55], v[128:131], v[100:103], v[52:55]
    v_mfma_f32_16x16x32_bf16 v[72:75], v[128:131], v[104:107], v[72:75]
    v_mfma_f32_16x16x32_bf16 v[92:95], v[128:131], v[108:111], v[92:95]
    buffer_load_dwordx4 v[124:127], v3, s[28:31], s58 offen offset:3072 sc1
    buffer_load_dwordx4 v[128:131], v8, s[28:31], s58 offen sc1
    s_lshl_b32 s59, s63, 14
    s_add_u32 s59, s59, s50
    s_cmp_eq_u32 s63, 13
    s_cselect_b32 s48, s52, 0
    s_add_u32 s59, s59, s48
    s_add_u32 s63, s63, 1
    s_cmp_eq_u32 s63, 14
    s_cselect_b32 s63, 0, s63
    buffer_load_dwordx4 v[96:99], v4, s[28:31], s59 offen sc1
    buffer_load_dwordx4 v[100:103], v5, s[28:31], s59 offen sc1
    buffer_load_dwordx4 v[104:107], v6, s[28:31], s59 offen sc1
    buffer_load_dwordx4 v[108:111], v7, s[28:31], s59 offen sc1
    s_waitcnt vmcnt(18)
    v_mfma_f32_16x16x32_bf16 v[16:19], v[148:151], v[132:135], v[16:19]
    v_mfma_f32_16x16x32_bf16 v[36:39], v[148:151], v[136:139], v[36:39]
    v_mfma_f32_16x16x32_bf16 v[56:59], v[148:151], v[140:143], v[56:59]
    v_mfma_f32_16x16x32_bf16 v[76:79], v[148:151], v[144:147], v[76:79]
    v_mfma_f32_16x16x32_bf16 v[20:23], v[152:155], v[132:135], v[20:23]
    v_mfma_f32_16x16x32_bf16 v[40:43], v[152:155], v[136:139], v[40:43]
    v_mfma_f32_16x16x32_bf16 v[60:63], v[152:155], v[140:143], v[60:63]
    v_mfma_f32_16x16x32_bf16 v[80:83], v[152:155], v[144:147], v[80:83]
    s_mul_i32 s58, s62, 20480
    s_add_u32 s58, s58, s51
    s_cmp_eq_u32 s62, 13
    s_cselect_b32 s48, s52, 0
    s_add_u32 s58, s58, s48
    s_add_u32 s62, s62, 1
    s_cmp_eq_u32 s62, 14
    s_cselect_b32 s62, 0, s62
    buffer_load_dwordx4 v[148:151], v3, s[28:31], s58 offen offset:0 sc1
    v_mfma_f32_16x16x32_bf16 v[24:27], v[156:159], v[132:135], v[24:27]
    v_mfma_f32_16x16x32_bf16 v[44:47], v[156:159], v[136:139], v[44:47]
    v_mfma_f32_16x16x32_bf16 v[64:67], v[156:159], v[140:143], v[64:67]
    v_mfma_f32_16x16x32_bf16 v[84:87], v[156:159], v[144:147], v[84:87]
    buffer_load_dwordx4 v[152:155], v3, s[28:31], s58 offen offset:1024 sc1
    v_mfma_f32_16x16x32_bf16 v[28:31], v[160:163], v[132:135], v[28:31]
    v_mfma_f32_16x16x32_bf16 v[48:51], v[160:163], v[136:139], v[48:51]
    v_mfma_f32_16x16x32_bf16 v[68:71], v[160:163], v[140:143], v[68:71]
    v_mfma_f32_16x16x32_bf16 v[88:91], v[160:163], v[144:147], v[88:91]
    buffer_load_dwordx4 v[156:159], v3, s[28:31], s58 offen offset:2048 sc1
    v_mfma_f32_16x16x32_bf16 v[32:35], v[164:167], v[132:135], v[32:35]
    v_mfma_f32_16x16x32_bf16 v[52:55], v[164:167], v[136:139], v[52:55]
    v_mfma_f32_16x16x32_bf16 v[72:75], v[164:167], v[140:143], v[72:75]
    v_mfma_f32_16x16x32_bf16 v[92:95], v[164:167], v[144:147], v[92:95]
    buffer_load_dwordx4 v[160:163], v3, s[28:31], s58 offen offset:3072 sc1
    buffer_load_dwordx4 v[164:167], v8, s[28:31], s58 offen sc1
    s_lshl_b32 s59, s63, 14
    s_add_u32 s59, s59, s50
    s_cmp_eq_u32 s63, 13
    s_cselect_b32 s48, s52, 0
    s_add_u32 s59, s59, s48
    s_add_u32 s63, s63, 1
    s_cmp_eq_u32 s63, 14
    s_cselect_b32 s63, 0, s63
    buffer_load_dwordx4 v[132:135], v4, s[28:31], s59 offen sc1
    buffer_load_dwordx4 v[136:139], v5, s[28:31], s59 offen sc1
    buffer_load_dwordx4 v[140:143], v6, s[28:31], s59 offen sc1
    buffer_load_dwordx4 v[144:147], v7, s[28:31], s59 offen sc1
    s_waitcnt vmcnt(23)
    v_mfma_f32_16x16x32_bf16 v[16:19], v[184:187], v[168:171], v[16:19]
    v_mfma_f32_16x16x32_bf16 v[36:39], v[184:187], v[172:175], v[36:39]
    v_mfma_f32_16x16x32_bf16 v[56:59], v[184:187], v[176:179], v[56:59]
    v_mfma_f32_16x16x32_bf16 v[76:79], v[184:187], v[180:183], v[76:79]
    v_mfma_f32_16x16x32_bf16 v[20:23], v[188:191], v[168:171], v[20:23]
    v_mfma_f32_16x16x32_bf16 v[40:43], v[188:191], v[172:175], v[40:43]
    v_mfma_f32_16x16x32_bf16 v[60:63], v[188:191], v[176:179], v[60:63]
    v_mfma_f32_16x16x32_bf16 v[80:83], v[188:191], v[180:183], v[80:83]
    s_mul_i32 s58, s62, 20480
    s_add_u32 s58, s58, s51
    s_cmp_eq_u32 s62, 13
    s_cselect_b32 s48, s52, 0
    s_add_u32 s58, s58, s48
    s_add_u32 s62, s62, 1
    s_cmp_eq_u32 s62, 14
    s_cselect_b32 s62, 0, s62
    buffer_load_dwordx4 v[184:187], v3, s[28:31], s58 offen offset:0 sc1
    v_mfma_f32_16x16x32_bf16 v[24:27], v[192:195], v[168:171], v[24:27]
    v_mfma_f32_16x16x32_bf16 v[44:47], v[192:195], v[172:175], v[44:47]
    v_mfma_f32_16x16x32_bf16 v[64:67], v[192:195], v[176:179], v[64:67]
    v_mfma_f32_16x16x32_bf16 v[84:87], v[192:195], v[180:183], v[84:87]
    buffer_load_dwordx4 v[188:191], v3, s[28:31], s58 offen offset:1024 sc1
    v_mfma_f32_16x16x32_bf16 v[28:31], v[196:199], v[168:171], v[28:31]
    v_mfma_f32_16x16x32_bf16 v[48:51], v[196:199], v[172:175], v[48:51]
    v_mfma_f32_16x16x32_bf16 v[68:71], v[196:199], v[176:179], v[68:71]
    v_mfma_f32_16x16x32_bf16 v[88:91], v[196:199], v[180:183], v[88:91]
    buffer_load_dwordx4 v[192:195], v3, s[28:31], s58 offen offset:2048 sc1
    v_mfma_f32_16x16x32_bf16 v[32:35], v[200:203], v[168:171], v[32:35]
    v_mfma_f32_16x16x32_bf16 v[52:55], v[200:203], v[172:175], v[52:55]
    v_mfma_f32_16x16x32_bf16 v[72:75], v[200:203], v[176:179], v[72:75]
    v_mfma_f32_16x16x32_bf16 v[92:95], v[200:203], v[180:183], v[92:95]
    buffer_load_dwordx4 v[196:199], v3, s[28:31], s58 offen offset:3072 sc1
    buffer_load_dwordx4 v[200:203], v8, s[28:31], s58 offen sc1
    s_lshl_b32 s59, s63, 14
    s_add_u32 s59, s59, s50
    s_cmp_eq_u32 s63, 13
    s_cselect_b32 s48, s52, 0
    s_add_u32 s59, s59, s48
    s_add_u32 s63, s63, 1
    s_cmp_eq_u32 s63, 14
    s_cselect_b32 s63, 0, s63
    buffer_load_dwordx4 v[168:171], v4, s[28:31], s59 offen sc1
    buffer_load_dwordx4 v[172:175], v5, s[28:31], s59 offen sc1
    buffer_load_dwordx4 v[176:179], v6, s[28:31], s59 offen sc1
    buffer_load_dwordx4 v[180:183], v7, s[28:31], s59 offen sc1
    s_waitcnt vmcnt(28)
    v_mfma_f32_16x16x32_bf16 v[16:19], v[220:223], v[204:207], v[16:19]
    v_mfma_f32_16x16x32_bf16 v[36:39], v[220:223], v[208:211], v[36:39]
    v_mfma_f32_16x16x32_bf16 v[56:59], v[220:223], v[212:215], v[56:59]
    v_mfma_f32_16x16x32_bf16 v[76:79], v[220:223], v[216:219], v[76:79]
    v_mfma_f32_16x16x32_bf16 v[20:23], v[224:227], v[204:207], v[20:23]
    v_mfma_f32_16x16x32_bf16 v[40:43], v[224:227], v[208:211], v[40:43]
    v_mfma_f32_16x16x32_bf16 v[60:63], v[224:227], v[212:215], v[60:63]
    v_mfma_f32_16x16x32_bf16 v[80:83], v[224:227], v[216:219], v[80:83]
    s_mul_i32 s58, s62, 20480
    s_add_u32 s58, s58, s51
    s_cmp_eq_u32 s62, 13
    s_cselect_b32 s48, s52, 0
    s_add_u32 s58, s58, s48
    s_add_u32 s62, s62, 1
    s_cmp_eq_u32 s62, 14
    s_cselect_b32 s62, 0, s62
    buffer_load_dwordx4 v[220:223], v3, s[28:31], s58 offen offset:0 sc1
    v_mfma_f32_16x16x32_bf16 v[24:27], v[228:231], v[204:207], v[24:27]
    v_mfma_f32_16x16x32_bf16 v[44:47], v[228:231], v[208:211], v[44:47]
    v_mfma_f32_16x16x32_bf16 v[64:67], v[228:231], v[212:215], v[64:67]
    v_mfma_f32_16x16x32_bf16 v[84:87], v[228:231], v[216:219], v[84:87]
    buffer_load_dwordx4 v[224:227], v3, s[28:31], s58 offen offset:1024 sc1
    v_mfma_f32_16x16x32_bf16 v[28:31], v[232:235], v[204:207], v[28:31]
    v_mfma_f32_16x16x32_bf16 v[48:51], v[232:235], v[208:211], v[48:51]
    v_mfma_f32_16x16x32_bf16 v[68:71], v[232:235], v[212:215], v[68:71]
    v_mfma_f32_16x16x32_bf16 v[88:91], v[232:235], v[216:219], v[88:91]
    buffer_load_dwordx4 v[228:231], v3, s[28:31], s58 offen offset:2048 sc1
    v_mfma_f32_16x16x32_bf16 v[32:35], v[236:239], v[204:207], v[32:35]
    v_mfma_f32_16x16x32_bf16 v[52:55], v[236:239], v[208:211], v[52:55]
    v_mfma_f32_16x16x32_bf16 v[72:75], v[236:239], v[212:215], v[72:75]
    v_mfma_f32_16x16x32_bf16 v[92:95], v[236:239], v[216:219], v[92:95]
    buffer_load_dwordx4 v[232:235], v3, s[28:31], s58 offen offset:3072 sc1
    buffer_load_dwordx4 v[236:239], v8, s[28:31], s58 offen sc1
    s_lshl_b32 s59, s63, 14
    s_add_u32 s59, s59, s50
    s_cmp_eq_u32 s63, 13
    s_cselect_b32 s48, s52, 0
    s_add_u32 s59, s59, s48
    s_add_u32 s63, s63, 1
    s_cmp_eq_u32 s63, 14
    s_cselect_b32 s63, 0, s63
    buffer_load_dwordx4 v[204:207], v4, s[28:31], s59 offen sc1
    buffer_load_dwordx4 v[208:211], v5, s[28:31], s59 offen sc1
    buffer_load_dwordx4 v[212:215], v6, s[28:31], s59 offen sc1
    buffer_load_dwordx4 v[216:219], v7, s[28:31], s59 offen sc1
    s_waitcnt vmcnt(27)
    v_mfma_f32_16x16x32_bf16 v[16:19], v[112:115], v[96:99], v[16:19]
    v_mfma_f32_16x16x32_bf16 v[36:39], v[112:115], v[100:103], v[36:39]
    v_mfma_f32_16x16x32_bf16 v[56:59], v[112:115], v[104:107], v[56:59]
    v_mfma_f32_16x16x32_bf16 v[76:79], v[112:115], v[108:111], v[76:79]
    v_mfma_f32_16x16x32_bf16 v[20:23], v[116:119], v[96:99], v[20:23]
    v_mfma_f32_16x16x32_bf16 v[40:43], v[116:119], v[100:103], v[40:43]
    v_mfma_f32_16x16x32_bf16 v[60:63], v[116:119], v[104:107], v[60:63]
    v_mfma_f32_16x16x32_bf16 v[80:83], v[116:119], v[108:111], v[80:83]
    s_mul_i32 s58, s62, 20480
    s_add_u32 s58, s58, s51
    s_cmp_eq_u32 s62, 13
    s_cselect_b32 s48, s52, 0
    s_add_u32 s58, s58, s48
    s_add_u32 s62, s62, 1
    s_cmp_eq_u32 s62, 14
    s_cselect_b32 s62, 0, s62
    buffer_load_dwordx4 v[112:115], v3, s[28:31], s58 offen offset:0 sc1
    v_mfma_f32_16x16x32_bf16 v[24:27], v[120:123], v[96:99], v[24:27]
    v_mfma_f32_16x16x32_bf16 v[44:47], v[120:123], v[100:103], v[44:47]
    v_mfma_f32_16x16x32_bf16 v[64:67], v[120:123], v[104:107], v[64:67]
    v_mfma_f32_16x16x32_bf16 v[84:87], v[120:123], v[108:111], v[84:87]
    buffer_load_dwordx4 v[116:119], v3, s[28:31], s58 offen offset:1024 sc1
    v_mfma_f32_16x16x32_bf16 v[28:31], v[124:127], v[96:99], v[28:31]
    v_mfma_f32_16x16x32_bf16 v[48:51], v[124:127], v[100:103], v[48:51]
    v_mfma_f32_16x16x32_bf16 v[68:71], v[124:127], v[104:107], v[68:71]
    v_mfma_f32_16x16x32_bf16 v[88:91], v[124:127], v[108:111], v[88:91]
    buffer_load_dwordx4 v[120:123], v3, s[28:31], s58 offen offset:2048 sc1
    v_mfma_f32_16x16x32_bf16 v[32:35], v[128:131], v[96:99], v[32:35]
    v_mfma_f32_16x16x32_bf16 v[52:55], v[128:131], v[100:103], v[52:55]
    v_mfma_f32_16x16x32_bf16 v[72:75], v[128:131], v[104:107], v[72:75]
    v_mfma_f32_16x16x32_bf16 v[92:95], v[128:131], v[108:111], v[92:95]
    buffer_load_dwordx4 v[124:127], v3, s[28:31], s58 offen offset:3072 sc1
    buffer_load_dwordx4 v[128:131], v8, s[28:31], s58 offen sc1
    s_lshl_b32 s59, s63, 14
    s_add_u32 s59, s59, s50
    s_cmp_eq_u32 s63, 13
    s_cselect_b32 s48, s52, 0
    s_add_u32 s59, s59, s48
    s_add_u32 s63, s63, 1
    s_cmp_eq_u32 s63, 14
    s_cselect_b32 s63, 0, s63
    buffer_load_dwordx4 v[96:99], v4, s[28:31], s59 offen sc1
    buffer_load_dwordx4 v[100:103], v5, s[28:31], s59 offen sc1
    buffer_load_dwordx4 v[104:107], v6, s[28:31], s59 offen sc1
    buffer_load_dwordx4 v[108:111], v7, s[28:31], s59 offen sc1
    s_waitcnt vmcnt(27)
    v_mfma_f32_16x16x32_bf16 v[16:19], v[148:151], v[132:135], v[16:19]
    v_mfma_f32_16x16x32_bf16 v[36:39], v[148:151], v[136:139], v[36:39]
    v_mfma_f32_16x16x32_bf16 v[56:59], v[148:151], v[140:143], v[56:59]
    v_mfma_f32_16x16x32_bf16 v[76:79], v[148:151], v[144:147], v[76:79]
    v_mfma_f32_16x16x32_bf16 v[20:23], v[152:155], v[132:135], v[20:23]
    v_mfma_f32_16x16x32_bf16 v[40:43], v[152:155], v[136:139], v[40:43]
    v_mfma_f32_16x16x32_bf16 v[60:63], v[152:155], v[140:143], v[60:63]
    v_mfma_f32_16x16x32_bf16 v[80:83], v[152:155], v[144:147], v[80:83]
    s_mul_i32 s58, s62, 20480
    s_add_u32 s58, s58, s51
    s_cmp_eq_u32 s62, 13
    s_cselect_b32 s48, s52, 0
    s_add_u32 s58, s58, s48
    s_add_u32 s62, s62, 1
    s_cmp_eq_u32 s62, 14
    s_cselect_b32 s62, 0, s62
    buffer_load_dwordx4 v[148:151], v3, s[28:31], s58 offen offset:0 sc1
    v_mfma_f32_16x16x32_bf16 v[24:27], v[156:159], v[132:135], v[24:27]
    v_mfma_f32_16x16x32_bf16 v[44:47], v[156:159], v[136:139], v[44:47]
    v_mfma_f32_16x16x32_bf16 v[64:67], v[156:159], v[140:143], v[64:67]
    v_mfma_f32_16x16x32_bf16 v[84:87], v[156:159], v[144:147], v[84:87]
    buffer_load_dwordx4 v[152:155], v3, s[28:31], s58 offen offset:1024 sc1
    v_mfma_f32_16x16x32_bf16 v[28:31], v[160:163], v[132:135], v[28:31]
    v_mfma_f32_16x16x32_bf16 v[48:51], v[160:163], v[136:139], v[48:51]
    v_mfma_f32_16x16x32_bf16 v[68:71], v[160:163], v[140:143], v[68:71]
    v_mfma_f32_16x16x32_bf16 v[88:91], v[160:163], v[144:147], v[88:91]
    buffer_load_dwordx4 v[156:159], v3, s[28:31], s58 offen offset:2048 sc1
    v_mfma_f32_16x16x32_bf16 v[32:35], v[164:167], v[132:135], v[32:35]
    v_mfma_f32_16x16x32_bf16 v[52:55], v[164:167], v[136:139], v[52:55]
    v_mfma_f32_16x16x32_bf16 v[72:75], v[164:167], v[140:143], v[72:75]
    v_mfma_f32_16x16x32_bf16 v[92:95], v[164:167], v[144:147], v[92:95]
    buffer_load_dwordx4 v[160:163], v3, s[28:31], s58 offen offset:3072 sc1
    buffer_load_dwordx4 v[164:167], v8, s[28:31], s58 offen sc1
    s_lshl_b32 s59, s63, 14
    s_add_u32 s59, s59, s50
    s_cmp_eq_u32 s63, 13
    s_cselect_b32 s48, s52, 0
    s_add_u32 s59, s59, s48
    s_add_u32 s63, s63, 1
    s_cmp_eq_u32 s63, 14
    s_cselect_b32 s63, 0, s63
    buffer_load_dwordx4 v[132:135], v4, s[28:31], s59 offen sc1
    buffer_load_dwordx4 v[136:139], v5, s[28:31], s59 offen sc1
    buffer_load_dwordx4 v[140:143], v6, s[28:31], s59 offen sc1
    buffer_load_dwordx4 v[144:147], v7, s[28:31], s59 offen sc1
    s_waitcnt vmcnt(27)
    v_mfma_f32_16x16x32_bf16 v[16:19], v[184:187], v[168:171], v[16:19]
    v_mfma_f32_16x16x32_bf16 v[36:39], v[184:187], v[172:175], v[36:39]
    v_mfma_f32_16x16x32_bf16 v[56:59], v[184:187], v[176:179], v[56:59]
    v_mfma_f32_16x16x32_bf16 v[76:79], v[184:187], v[180:183], v[76:79]
    v_mfma_f32_16x16x32_bf16 v[20:23], v[188:191], v[168:171], v[20:23]
    v_mfma_f32_16x16x32_bf16 v[40:43], v[188:191], v[172:175], v[40:43]
    v_mfma_f32_16x16x32_bf16 v[60:63], v[188:191], v[176:179], v[60:63]
    v_mfma_f32_16x16x32_bf16 v[80:83], v[188:191], v[180:183], v[80:83]
    s_mul_i32 s58, s62, 20480
    s_add_u32 s58, s58, s51
    s_cmp_eq_u32 s62, 13
    s_cselect_b32 s48, s52, 0
    s_add_u32 s58, s58, s48
    s_add_u32 s62, s62, 1
    s_cmp_eq_u32 s62, 14
    s_cselect_b32 s62, 0, s62
    buffer_load_dwordx4 v[184:187], v3, s[28:31], s58 offen offset:0 sc1
    v_mfma_f32_16x16x32_bf16 v[24:27], v[192:195], v[168:171], v[24:27]
    v_mfma_f32_16x16x32_bf16 v[44:47], v[192:195], v[172:175], v[44:47]
    v_mfma_f32_16x16x32_bf16 v[64:67], v[192:195], v[176:179], v[64:67]
    v_mfma_f32_16x16x32_bf16 v[84:87], v[192:195], v[180:183], v[84:87]
    buffer_load_dwordx4 v[188:191], v3, s[28:31], s58 offen offset:1024 sc1
    v_mfma_f32_16x16x32_bf16 v[28:31], v[196:199], v[168:171], v[28:31]
    v_mfma_f32_16x16x32_bf16 v[48:51], v[196:199], v[172:175], v[48:51]
    v_mfma_f32_16x16x32_bf16 v[68:71], v[196:199], v[176:179], v[68:71]
    v_mfma_f32_16x16x32_bf16 v[88:91], v[196:199], v[180:183], v[88:91]
    buffer_load_dwordx4 v[192:195], v3, s[28:31], s58 offen offset:2048 sc1
    v_mfma_f32_16x16x32_bf16 v[32:35], v[200:203], v[168:171], v[32:35]
    v_mfma_f32_16x16x32_bf16 v[52:55], v[200:203], v[172:175], v[52:55]
    v_mfma_f32_16x16x32_bf16 v[72:75], v[200:203], v[176:179], v[72:75]
    v_mfma_f32_16x16x32_bf16 v[92:95], v[200:203], v[180:183], v[92:95]
    buffer_load_dwordx4 v[196:199], v3, s[28:31], s58 offen offset:3072 sc1
    buffer_load_dwordx4 v[200:203], v8, s[28:31], s58 offen sc1
    s_lshl_b32 s59, s63, 14
    s_add_u32 s59, s59, s50
    s_cmp_eq_u32 s63, 13
    s_cselect_b32 s48, s52, 0
    s_add_u32 s59, s59, s48
    s_add_u32 s63, s63, 1
    s_cmp_eq_u32 s63, 14
    s_cselect_b32 s63, 0, s63
    buffer_load_dwordx4 v[168:171], v4, s[28:31], s59 offen sc1
    buffer_load_dwordx4 v[172:175], v5, s[28:31], s59 offen sc1
    buffer_load_dwordx4 v[176:179], v6, s[28:31], s59 offen sc1
    buffer_load_dwordx4 v[180:183], v7, s[28:31], s59 offen sc1
    s_waitcnt vmcnt(27)
    v_mfma_f32_16x16x32_bf16 v[16:19], v[220:223], v[204:207], v[16:19]
    v_mfma_f32_16x16x32_bf16 v[36:39], v[220:223], v[208:211], v[36:39]
    v_mfma_f32_16x16x32_bf16 v[56:59], v[220:223], v[212:215], v[56:59]
    v_mfma_f32_16x16x32_bf16 v[76:79], v[220:223], v[216:219], v[76:79]
    v_mfma_f32_16x16x32_bf16 v[20:23], v[224:227], v[204:207], v[20:23]
    v_mfma_f32_16x16x32_bf16 v[40:43], v[224:227], v[208:211], v[40:43]
    v_mfma_f32_16x16x32_bf16 v[60:63], v[224:227], v[212:215], v[60:63]
    v_mfma_f32_16x16x32_bf16 v[80:83], v[224:227], v[216:219], v[80:83]
    s_mul_i32 s58, s62, 20480
    s_add_u32 s58, s58, s51
    s_cmp_eq_u32 s62, 13
    s_cselect_b32 s48, s52, 0
    s_add_u32 s58, s58, s48
    s_add_u32 s62, s62, 1
    s_cmp_eq_u32 s62, 14
    s_cselect_b32 s62, 0, s62
    buffer_load_dwordx4 v[220:223], v3, s[28:31], s58 offen offset:0 sc1
    v_mfma_f32_16x16x32_bf16 v[24:27], v[228:231], v[204:207], v[24:27]
    v_mfma_f32_16x16x32_bf16 v[44:47], v[228:231], v[208:211], v[44:47]
    v_mfma_f32_16x16x32_bf16 v[64:67], v[228:231], v[212:215], v[64:67]
    v_mfma_f32_16x16x32_bf16 v[84:87], v[228:231], v[216:219], v[84:87]
    buffer_load_dwordx4 v[224:227], v3, s[28:31], s58 offen offset:1024 sc1
    v_mfma_f32_16x16x32_bf16 v[28:31], v[232:235], v[204:207], v[28:31]
    v_mfma_f32_16x16x32_bf16 v[48:51], v[232:235], v[208:211], v[48:51]
    v_mfma_f32_16x16x32_bf16 v[68:71], v[232:235], v[212:215], v[68:71]
    v_mfma_f32_16x16x32_bf16 v[88:91], v[232:235], v[216:219], v[88:91]
    buffer_load_dwordx4 v[228:231], v3, s[28:31], s58 offen offset:2048 sc1
    v_mfma_f32_16x16x32_bf16 v[32:35], v[236:239], v[204:207], v[32:35]
    v_mfma_f32_16x16x32_bf16 v[52:55], v[236:239], v[208:211], v[52:55]
    v_mfma_f32_16x16x32_bf16 v[72:75], v[236:239], v[212:215], v[72:75]
    v_mfma_f32_16x16x32_bf16 v[92:95], v[236:239], v[216:219], v[92:95]
    buffer_load_dwordx4 v[232:235], v3, s[28:31], s58 offen offset:3072 sc1
    buffer_load_dwordx4 v[236:239], v8, s[28:31], s58 offen sc1
    s_lshl_b32 s59, s63, 14
    s_add_u32 s59, s59, s50
    s_cmp_eq_u32 s63, 13
    s_cselect_b32 s48, s52, 0
    s_add_u32 s59, s59, s48
    s_add_u32 s63, s63, 1
    s_cmp_eq_u32 s63, 14
    s_cselect_b32 s63, 0, s63
    buffer_load_dwordx4 v[204:207], v4, s[28:31], s59 offen sc1
    buffer_load_dwordx4 v[208:211], v5, s[28:31], s59 offen sc1
    buffer_load_dwordx4 v[212:215], v6, s[28:31], s59 offen sc1
    buffer_load_dwordx4 v[216:219], v7, s[28:31], s59 offen sc1
    s_waitcnt vmcnt(27)
    v_mfma_f32_16x16x32_bf16 v[16:19], v[112:115], v[96:99], v[16:19]
    v_mfma_f32_16x16x32_bf16 v[36:39], v[112:115], v[100:103], v[36:39]
    v_mfma_f32_16x16x32_bf16 v[56:59], v[112:115], v[104:107], v[56:59]
    v_mfma_f32_16x16x32_bf16 v[76:79], v[112:115], v[108:111], v[76:79]
    v_mfma_f32_16x16x32_bf16 v[20:23], v[116:119], v[96:99], v[20:23]
    v_mfma_f32_16x16x32_bf16 v[40:43], v[116:119], v[100:103], v[40:43]
    v_mfma_f32_16x16x32_bf16 v[60:63], v[116:119], v[104:107], v[60:63]
    v_mfma_f32_16x16x32_bf16 v[80:83], v[116:119], v[108:111], v[80:83]
    s_mul_i32 s58, s62, 20480
    s_add_u32 s58, s58, s51
    s_cmp_eq_u32 s62, 13
    s_cselect_b32 s48, s52, 0
    s_add_u32 s58, s58, s48
    s_add_u32 s62, s62, 1
    s_cmp_eq_u32 s62, 14
    s_cselect_b32 s62, 0, s62
    buffer_load_dwordx4 v[112:115], v3, s[28:31], s58 offen offset:0 sc1
    v_mfma_f32_16x16x32_bf16 v[24:27], v[120:123], v[96:99], v[24:27]
    v_mfma_f32_16x16x32_bf16 v[44:47], v[120:123], v[100:103], v[44:47]
    v_mfma_f32_16x16x32_bf16 v[64:67], v[120:123], v[104:107], v[64:67]
    v_mfma_f32_16x16x32_bf16 v[84:87], v[120:123], v[108:111], v[84:87]
    buffer_load_dwordx4 v[116:119], v3, s[28:31], s58 offen offset:1024 sc1
    v_mfma_f32_16x16x32_bf16 v[28:31], v[124:127], v[96:99], v[28:31]
    v_mfma_f32_16x16x32_bf16 v[48:51], v[124:127], v[100:103], v[48:51]
    v_mfma_f32_16x16x32_bf16 v[68:71], v[124:127], v[104:107], v[68:71]
    v_mfma_f32_16x16x32_bf16 v[88:91], v[124:127], v[108:111], v[88:91]
    buffer_load_dwordx4 v[120:123], v3, s[28:31], s58 offen offset:2048 sc1
    v_mfma_f32_16x16x32_bf16 v[32:35], v[128:131], v[96:99], v[32:35]
    v_mfma_f32_16x16x32_bf16 v[52:55], v[128:131], v[100:103], v[52:55]
    v_mfma_f32_16x16x32_bf16 v[72:75], v[128:131], v[104:107], v[72:75]
    v_mfma_f32_16x16x32_bf16 v[92:95], v[128:131], v[108:111], v[92:95]
    buffer_load_dwordx4 v[124:127], v3, s[28:31], s58 offen offset:3072 sc1
    buffer_load_dwordx4 v[128:131], v8, s[28:31], s58 offen sc1
    s_lshl_b32 s59, s63, 14
    s_add_u32 s59, s59, s50
    s_cmp_eq_u32 s63, 13
    s_cselect_b32 s48, s52, 0
    s_add_u32 s59, s59, s48
    s_add_u32 s63, s63, 1
    s_cmp_eq_u32 s63, 14
    s_cselect_b32 s63, 0, s63
    buffer_load_dwordx4 v[96:99], v4, s[28:31], s59 offen sc1
    buffer_load_dwordx4 v[100:103], v5, s[28:31], s59 offen sc1
    buffer_load_dwordx4 v[104:107], v6, s[28:31], s59 offen sc1
    buffer_load_dwordx4 v[108:111], v7, s[28:31], s59 offen sc1
    s_waitcnt vmcnt(27)
    v_mfma_f32_16x16x32_bf16 v[16:19], v[148:151], v[132:135], v[16:19]
    v_mfma_f32_16x16x32_bf16 v[36:39], v[148:151], v[136:139], v[36:39]
    v_mfma_f32_16x16x32_bf16 v[56:59], v[148:151], v[140:143], v[56:59]
    v_mfma_f32_16x16x32_bf16 v[76:79], v[148:151], v[144:147], v[76:79]
    v_mfma_f32_16x16x32_bf16 v[20:23], v[152:155], v[132:135], v[20:23]
    v_mfma_f32_16x16x32_bf16 v[40:43], v[152:155], v[136:139], v[40:43]
    v_mfma_f32_16x16x32_bf16 v[60:63], v[152:155], v[140:143], v[60:63]
    v_mfma_f32_16x16x32_bf16 v[80:83], v[152:155], v[144:147], v[80:83]
    s_mul_i32 s58, s62, 20480
    s_add_u32 s58, s58, s51
    s_cmp_eq_u32 s62, 13
    s_cselect_b32 s48, s52, 0
    s_add_u32 s58, s58, s48
    s_add_u32 s62, s62, 1
    s_cmp_eq_u32 s62, 14
    s_cselect_b32 s62, 0, s62
    buffer_load_dwordx4 v[148:151], v3, s[28:31], s58 offen offset:0 sc1
    v_mfma_f32_16x16x32_bf16 v[24:27], v[156:159], v[132:135], v[24:27]
    v_mfma_f32_16x16x32_bf16 v[44:47], v[156:159], v[136:139], v[44:47]
    v_mfma_f32_16x16x32_bf16 v[64:67], v[156:159], v[140:143], v[64:67]
    v_mfma_f32_16x16x32_bf16 v[84:87], v[156:159], v[144:147], v[84:87]
    buffer_load_dwordx4 v[152:155], v3, s[28:31], s58 offen offset:1024 sc1
    v_mfma_f32_16x16x32_bf16 v[28:31], v[160:163], v[132:135], v[28:31]
    v_mfma_f32_16x16x32_bf16 v[48:51], v[160:163], v[136:139], v[48:51]
    v_mfma_f32_16x16x32_bf16 v[68:71], v[160:163], v[140:143], v[68:71]
    v_mfma_f32_16x16x32_bf16 v[88:91], v[160:163], v[144:147], v[88:91]
    buffer_load_dwordx4 v[156:159], v3, s[28:31], s58 offen offset:2048 sc1
    v_mfma_f32_16x16x32_bf16 v[32:35], v[164:167], v[132:135], v[32:35]
    v_mfma_f32_16x16x32_bf16 v[52:55], v[164:167], v[136:139], v[52:55]
    v_mfma_f32_16x16x32_bf16 v[72:75], v[164:167], v[140:143], v[72:75]
    v_mfma_f32_16x16x32_bf16 v[92:95], v[164:167], v[144:147], v[92:95]
    buffer_load_dwordx4 v[160:163], v3, s[28:31], s58 offen offset:3072 sc1
    buffer_load_dwordx4 v[164:167], v8, s[28:31], s58 offen sc1
    s_lshl_b32 s59, s63, 14
    s_add_u32 s59, s59, s50
    s_cmp_eq_u32 s63, 13
    s_cselect_b32 s48, s52, 0
    s_add_u32 s59, s59, s48
    s_add_u32 s63, s63, 1
    s_cmp_eq_u32 s63, 14
    s_cselect_b32 s63, 0, s63
    buffer_load_dwordx4 v[132:135], v4, s[28:31], s59 offen sc1
    buffer_load_dwordx4 v[136:139], v5, s[28:31], s59 offen sc1
    buffer_load_dwordx4 v[140:143], v6, s[28:31], s59 offen sc1
    buffer_load_dwordx4 v[144:147], v7, s[28:31], s59 offen sc1
    s_waitcnt vmcnt(27)
    v_mfma_f32_16x16x32_bf16 v[16:19], v[184:187], v[168:171], v[16:19]
    v_mfma_f32_16x16x32_bf16 v[36:39], v[184:187], v[172:175], v[36:39]
    v_mfma_f32_16x16x32_bf16 v[56:59], v[184:187], v[176:179], v[56:59]
    v_mfma_f32_16x16x32_bf16 v[76:79], v[184:187], v[180:183], v[76:79]
    v_mfma_f32_16x16x32_bf16 v[20:23], v[188:191], v[168:171], v[20:23]
    v_mfma_f32_16x16x32_bf16 v[40:43], v[188:191], v[172:175], v[40:43]
    v_mfma_f32_16x16x32_bf16 v[60:63], v[188:191], v[176:179], v[60:63]
    v_mfma_f32_16x16x32_bf16 v[80:83], v[188:191], v[180:183], v[80:83]
    v_mfma_f32_16x16x32_bf16 v[24:27], v[192:195], v[168:171], v[24:27]
    v_mfma_f32_16x16x32_bf16 v[44:47], v[192:195], v[172:175], v[44:47]
    v_mfma_f32_16x16x32_bf16 v[64:67], v[192:195], v[176:179], v[64:67]
    v_mfma_f32_16x16x32_bf16 v[84:87], v[192:195], v[180:183], v[84:87]
    v_mfma_f32_16x16x32_bf16 v[28:31], v[196:199], v[168:171], v[28:31]
    v_mfma_f32_16x16x32_bf16 v[48:51], v[196:199], v[172:175], v[48:51]
    v_mfma_f32_16x16x32_bf16 v[68:71], v[196:199], v[176:179], v[68:71]
    v_mfma_f32_16x16x32_bf16 v[88:91], v[196:199], v[180:183], v[88:91]
    v_mfma_f32_16x16x32_bf16 v[32:35], v[200:203], v[168:171], v[32:35]
    v_mfma_f32_16x16x32_bf16 v[52:55], v[200:203], v[172:175], v[52:55]
    v_mfma_f32_16x16x32_bf16 v[72:75], v[200:203], v[176:179], v[72:75]
    v_mfma_f32_16x16x32_bf16 v[92:95], v[200:203], v[180:183], v[92:95]
    s_waitcnt vmcnt(18)
    v_mfma_f32_16x16x32_bf16 v[16:19], v[220:223], v[204:207], v[16:19]
    v_mfma_f32_16x16x32_bf16 v[36:39], v[220:223], v[208:211], v[36:39]
    v_mfma_f32_16x16x32_bf16 v[56:59], v[220:223], v[212:215], v[56:59]
    v_mfma_f32_16x16x32_bf16 v[76:79], v[220:223], v[216:219], v[76:79]
    v_mfma_f32_16x16x32_bf16 v[20:23], v[224:227], v[204:207], v[20:23]
    v_mfma_f32_16x16x32_bf16 v[40:43], v[224:227], v[208:211], v[40:43]
    v_mfma_f32_16x16x32_bf16 v[60:63], v[224:227], v[212:215], v[60:63]
    v_mfma_f32_16x16x32_bf16 v[80:83], v[224:227], v[216:219], v[80:83]
    v_mfma_f32_16x16x32_bf16 v[24:27], v[228:231], v[204:207], v[24:27]
    v_mfma_f32_16x16x32_bf16 v[44:47], v[228:231], v[208:211], v[44:47]
    v_mfma_f32_16x16x32_bf16 v[64:67], v[228:231], v[212:215], v[64:67]
    v_mfma_f32_16x16x32_bf16 v[84:87], v[228:231], v[216:219], v[84:87]
    v_mfma_f32_16x16x32_bf16 v[28:31], v[232:235], v[204:207], v[28:31]
    v_mfma_f32_16x16x32_bf16 v[48:51], v[232:235], v[208:211], v[48:51]
    v_mfma_f32_16x16x32_bf16 v[68:71], v[232:235], v[212:215], v[68:71]
    v_mfma_f32_16x16x32_bf16 v[88:91], v[232:235], v[216:219], v[88:91]
    v_mfma_f32_16x16x32_bf16 v[32:35], v[236:239], v[204:207], v[32:35]
    v_mfma_f32_16x16x32_bf16 v[52:55], v[236:239], v[208:211], v[52:55]
    v_mfma_f32_16x16x32_bf16 v[72:75], v[236:239], v[212:215], v[72:75]
    v_mfma_f32_16x16x32_bf16 v[92:95], v[236:239], v[216:219], v[92:95]
    s_waitcnt vmcnt(9)
    v_mfma_f32_16x16x32_bf16 v[16:19], v[112:115], v[96:99], v[16:19]
    v_mfma_f32_16x16x32_bf16 v[36:39], v[112:115], v[100:103], v[36:39]
    v_mfma_f32_16x16x32_bf16 v[56:59], v[112:115], v[104:107], v[56:59]
    v_mfma_f32_16x16x32_bf16 v[76:79], v[112:115], v[108:111], v[76:79]
    v_mfma_f32_16x16x32_bf16 v[20:23], v[116:119], v[96:99], v[20:23]
    v_mfma_f32_16x16x32_bf16 v[40:43], v[116:119], v[100:103], v[40:43]
    v_mfma_f32_16x16x32_bf16 v[60:63], v[116:119], v[104:107], v[60:63]
    v_mfma_f32_16x16x32_bf16 v[80:83], v[116:119], v[108:111], v[80:83]
    v_mfma_f32_16x16x32_bf16 v[24:27], v[120:123], v[96:99], v[24:27]
    v_mfma_f32_16x16x32_bf16 v[44:47], v[120:123], v[100:103], v[44:47]
    v_mfma_f32_16x16x32_bf16 v[64:67], v[120:123], v[104:107], v[64:67]
    v_mfma_f32_16x16x32_bf16 v[84:87], v[120:123], v[108:111], v[84:87]
    v_mfma_f32_16x16x32_bf16 v[28:31], v[124:127], v[96:99], v[28:31]
    v_mfma_f32_16x16x32_bf16 v[48:51], v[124:127], v[100:103], v[48:51]
    v_mfma_f32_16x16x32_bf16 v[68:71], v[124:127], v[104:107], v[68:71]
    v_mfma_f32_16x16x32_bf16 v[88:91], v[124:127], v[108:111], v[88:91]
    v_mfma_f32_16x16x32_bf16 v[32:35], v[128:131], v[96:99], v[32:35]
    v_mfma_f32_16x16x32_bf16 v[52:55], v[128:131], v[100:103], v[52:55]
    v_mfma_f32_16x16x32_bf16 v[72:75], v[128:131], v[104:107], v[72:75]
    v_mfma_f32_16x16x32_bf16 v[92:95], v[128:131], v[108:111], v[92:95]
    s_waitcnt vmcnt(0)
    v_mfma_f32_16x16x32_bf16 v[16:19], v[148:151], v[132:135], v[16:19]
    v_mfma_f32_16x16x32_bf16 v[36:39], v[148:151], v[136:139], v[36:39]
    v_mfma_f32_16x16x32_bf16 v[56:59], v[148:151], v[140:143], v[56:59]
    v_mfma_f32_16x16x32_bf16 v[76:79], v[148:151], v[144:147], v[76:79]
    v_mfma_f32_16x16x32_bf16 v[20:23], v[152:155], v[132:135], v[20:23]
    v_mfma_f32_16x16x32_bf16 v[40:43], v[152:155], v[136:139], v[40:43]
    v_mfma_f32_16x16x32_bf16 v[60:63], v[152:155], v[140:143], v[60:63]
    v_mfma_f32_16x16x32_bf16 v[80:83], v[152:155], v[144:147], v[80:83]
    v_mfma_f32_16x16x32_bf16 v[24:27], v[156:159], v[132:135], v[24:27]
    v_mfma_f32_16x16x32_bf16 v[44:47], v[156:159], v[136:139], v[44:47]
    v_mfma_f32_16x16x32_bf16 v[64:67], v[156:159], v[140:143], v[64:67]
    v_mfma_f32_16x16x32_bf16 v[84:87], v[156:159], v[144:147], v[84:87]
    v_mfma_f32_16x16x32_bf16 v[28:31], v[160:163], v[132:135], v[28:31]
    v_mfma_f32_16x16x32_bf16 v[48:51], v[160:163], v[136:139], v[48:51]
    v_mfma_f32_16x16x32_bf16 v[68:71], v[160:163], v[140:143], v[68:71]
    v_mfma_f32_16x16x32_bf16 v[88:91], v[160:163], v[144:147], v[88:91]
    v_mfma_f32_16x16x32_bf16 v[32:35], v[164:167], v[132:135], v[32:35]
    v_mfma_f32_16x16x32_bf16 v[52:55], v[164:167], v[136:139], v[52:55]
    v_mfma_f32_16x16x32_bf16 v[72:75], v[164:167], v[140:143], v[72:75]
    v_mfma_f32_16x16x32_bf16 v[92:95], v[164:167], v[144:147], v[92:95]
    s_mul_i32 s48, s3, 15360
    s_add_u32 s48, s48, 88320
    v_add_u32 v11, s48, v3
    ds_write_b128 v11, v[36:39] offset:0
    ds_write_b128 v11, v[40:43] offset:1024
    ds_write_b128 v11, v[44:47] offset:2048
    ds_write_b128 v11, v[48:51] offset:3072
    ds_write_b128 v11, v[52:55] offset:4096
    ds_write_b128 v11, v[56:59] offset:5120
    ds_write_b128 v11, v[60:63] offset:6144
    ds_write_b128 v11, v[64:67] offset:7168
    ds_write_b128 v11, v[68:71] offset:8192
    ds_write_b128 v11, v[72:75] offset:9216
    ds_write_b128 v11, v[76:79] offset:10240
    ds_write_b128 v11, v[80:83] offset:11264
    ds_write_b128 v11, v[84:87] offset:12288
    ds_write_b128 v11, v[88:91] offset:13312
    ds_write_b128 v11, v[92:95] offset:14336
    s_nop 1
    v_mul_u32_u24 v11, 160, v9
    v_lshl_add_u32 v11, v10, 3, v11
    v_add_u32 v11, s55, v11
    v_lshrrev_b32 v12, 2, v9
    v_lshl_add_u32 v12, v10, 2, v12
    v_lshlrev_b32 v12, 7, v12
    v_and_b32 v14, 3, v2
    v_lshl_add_u32 v12, v14, 3, v12
    s_lshl_b32 s48, s3, 5
    s_add_u32 s48, s48, 76032
    v_add_u32 v12, s48, v12
    v_mov_b32 v14, 1
    s_waitcnt lgkmcnt(0)
    s_mov_b64 exec, 1
    ds_add_u32 v13, v14 offset:4
    s_mov_b64 exec, -1
    ds_read_b64 v[160:161], v11 offset:0
    ds_read_b64 v[162:163], v11 offset:32
    ds_read_b64 v[164:165], v11 offset:64
    ds_read_b64 v[166:167], v11 offset:96
    ds_read_b64 v[168:169], v11 offset:128
    v_rcp_f32 v246, v245
    s_waitcnt lgkmcnt(0)
    v_lshlrev_b32 v200, 16, v160
    v_and_b32 v201, 0xffff0000, v160
    v_lshlrev_b32 v202, 16, v161
    v_and_b32 v203, 0xffff0000, v161
    v_sub_f32 v220, v200, v244
    v_sub_f32 v221, v201, v244
    v_sub_f32 v222, v202, v244
    v_sub_f32 v223, v203, v244
    v_cvt_pk_bf16_f32 v180, v220, v221
    v_lshlrev_b32 v220, 16, v180
    v_and_b32 v221, 0xffff0000, v180
    v_cvt_pk_bf16_f32 v181, v222, v223
    v_lshlrev_b32 v222, 16, v181
    v_and_b32 v223, 0xffff0000, v181
    v_mul_f32 v220, v220, v246
    v_mul_f32 v221, v221, v246
    v_mul_f32 v222, v222, v246
    v_mul_f32 v223, v223, v246
    v_cvt_pk_bf16_f32 v180, v220, v221
    v_lshlrev_b32 v220, 16, v180
    v_and_b32 v221, 0xffff0000, v180
    v_cvt_pk_bf16_f32 v181, v222, v223
    v_lshlrev_b32 v222, 16, v181
    v_and_b32 v223, 0xffff0000, v181
    v_lshlrev_b32 v204, 16, v162
    v_and_b32 v205, 0xffff0000, v162
    v_lshlrev_b32 v206, 16, v163
    v_and_b32 v207, 0xffff0000, v163
    v_sub_f32 v224, v204, v244
    v_sub_f32 v225, v205, v244
    v_sub_f32 v226, v206, v244
    v_sub_f32 v227, v207, v244
    v_cvt_pk_bf16_f32 v180, v224, v225
    v_lshlrev_b32 v224, 16, v180
    v_and_b32 v225, 0xffff0000, v180
    v_cvt_pk_bf16_f32 v181, v226, v227
    v_lshlrev_b32 v226, 16, v181
    v_and_b32 v227, 0xffff0000, v181
    v_mul_f32 v224, v224, v246
    v_mul_f32 v225, v225, v246
    v_mul_f32 v226, v226, v246
    v_mul_f32 v227, v227, v246
    v_cvt_pk_bf16_f32 v180, v224, v225
    v_lshlrev_b32 v224, 16, v180
    v_and_b32 v225, 0xffff0000, v180
    v_cvt_pk_bf16_f32 v181, v226, v227
    v_lshlrev_b32 v226, 16, v181
    v_and_b32 v227, 0xffff0000, v181
    v_lshlrev_b32 v208, 16, v164
    v_and_b32 v209, 0xffff0000, v164
    v_lshlrev_b32 v210, 16, v165
    v_and_b32 v211, 0xffff0000, v165
    v_sub_f32 v228, v208, v244
    v_sub_f32 v229, v209, v244
    v_sub_f32 v230, v210, v244
    v_sub_f32 v231, v211, v244
    v_cvt_pk_bf16_f32 v180, v228, v229
    v_lshlrev_b32 v228, 16, v180
    v_and_b32 v229, 0xffff0000, v180
    v_cvt_pk_bf16_f32 v181, v230, v231
    v_lshlrev_b32 v230, 16, v181
    v_and_b32 v231, 0xffff0000, v181
    v_mul_f32 v228, v228, v246
    v_mul_f32 v229, v229, v246
    v_mul_f32 v230, v230, v246
    v_mul_f32 v231, v231, v246
    v_cvt_pk_bf16_f32 v180, v228, v229
    v_lshlrev_b32 v228, 16, v180
    v_and_b32 v229, 0xffff0000, v180
    v_cvt_pk_bf16_f32 v181, v230, v231
    v_lshlrev_b32 v230, 16, v181
    v_and_b32 v231, 0xffff0000, v181
    v_lshlrev_b32 v212, 16, v166
    v_and_b32 v213, 0xffff0000, v166
    v_lshlrev_b32 v214, 16, v167
    v_and_b32 v215, 0xffff0000, v167
    v_sub_f32 v232, v212, v244
    v_sub_f32 v233, v213, v244
    v_sub_f32 v234, v214, v244
    v_sub_f32 v235, v215, v244
    v_cvt_pk_bf16_f32 v180, v232, v233
    v_lshlrev_b32 v232, 16, v180
    v_and_b32 v233, 0xffff0000, v180
    v_cvt_pk_bf16_f32 v181, v234, v235
    v_lshlrev_b32 v234, 16, v181
    v_and_b32 v235, 0xffff0000, v181
    v_mul_f32 v232, v232, v246
    v_mul_f32 v233, v233, v246
    v_mul_f32 v234, v234, v246
    v_mul_f32 v235, v235, v246
    v_cvt_pk_bf16_f32 v180, v232, v233
    v_lshlrev_b32 v232, 16, v180
    v_and_b32 v233, 0xffff0000, v180
    v_cvt_pk_bf16_f32 v181, v234, v235
    v_lshlrev_b32 v234, 16, v181
    v_and_b32 v235, 0xffff0000, v181
    v_lshlrev_b32 v216, 16, v168
    v_and_b32 v217, 0xffff0000, v168
    v_lshlrev_b32 v218, 16, v169
    v_and_b32 v219, 0xffff0000, v169
    v_sub_f32 v236, v216, v244
    v_sub_f32 v237, v217, v244
    v_sub_f32 v238, v218, v244
    v_sub_f32 v239, v219, v244
    v_cvt_pk_bf16_f32 v180, v236, v237
    v_lshlrev_b32 v236, 16, v180
    v_and_b32 v237, 0xffff0000, v180
    v_cvt_pk_bf16_f32 v181, v238, v239
    v_lshlrev_b32 v238, 16, v181
    v_and_b32 v239, 0xffff0000, v181
    v_mul_f32 v236, v236, v246
    v_mul_f32 v237, v237, v246
    v_mul_f32 v238, v238, v246
    v_mul_f32 v239, v239, v246
    v_cvt_pk_bf16_f32 v180, v236, v237
    v_lshlrev_b32 v236, 16, v180
    v_and_b32 v237, 0xffff0000, v180
    v_cvt_pk_bf16_f32 v181, v238, v239
    v_lshlrev_b32 v238, 16, v181
    v_and_b32 v239, 0xffff0000, v181
    s_mov_b32 s94, 0
F_SP12:
    ds_read_b32 v14, v13 offset:4
    s_waitcnt lgkmcnt(0)
    v_readfirstlane_b32 s48, v14
    s_cmp_ge_u32 s48, 4
    s_cbranch_scc1 F_SPD12
    s_sleep 1
    s_add_u32 s94, s94, 1
    s_cmp_lt_u32 s94, 0x400000
    s_cbranch_scc1 F_SP12
F_SPD12:
    s_sub_u32 s48, s3, 1
    s_and_b32 s48, s48, 3
    s_mul_i32 s48, s48, 15360
    s_add_u32 s48, s48, 88320
    v_add_u32 v5, s48, v3
    ds_read_b128 v[96:99], v5 offset:0
    ds_read_b128 v[100:103], v5 offset:1024
    ds_read_b128 v[104:107], v5 offset:2048
    ds_read_b128 v[108:111], v5 offset:3072
    ds_read_b128 v[112:115], v5 offset:4096
    s_sub_u32 s48, s3, 2
    s_and_b32 s48, s48, 3
    s_mul_i32 s48, s48, 15360
    s_add_u32 s48, s48, 88320
    v_add_u32 v6, s48, v3
    ds_read_b128 v[116:119], v6 offset:5120
    ds_read_b128 v[120:123], v6 offset:6144
    ds_read_b128 v[124:127], v6 offset:7168
    ds_read_b128 v[128:131], v6 offset:8192
    ds_read_b128 v[132:135], v6 offset:9216
    s_sub_u32 s48, s3, 3
    s_and_b32 s48, s48, 3
    s_mul_i32 s48, s48, 15360
    s_add_u32 s48, s48, 88320
    v_add_u32 v7, s48, v3
    ds_read_b128 v[136:139], v7 offset:10240
    ds_read_b128 v[140:143], v7 offset:11264
    ds_read_b128 v[144:147], v7 offset:12288
    ds_read_b128 v[148:151], v7 offset:13312
    ds_read_b128 v[152:155], v7 offset:14336
    s_waitcnt lgkmcnt(0)
    v_pk_add_f32 v[16:17], v[16:17], v[96:97]
    v_pk_add_f32 v[116:117], v[116:117], v[136:137]
    v_pk_add_f32 v[16:17], v[16:17], v[116:117]
    v_pk_add_f32 v[18:19], v[18:19], v[98:99]
    v_pk_add_f32 v[118:119], v[118:119], v[138:139]
    v_pk_add_f32 v[18:19], v[18:19], v[118:119]
    v_pk_add_f32 v[20:21], v[20:21], v[100:101]
    v_pk_add_f32 v[120:121], v[120:121], v[140:141]
    v_pk_add_f32 v[20:21], v[20:21], v[120:121]
    v_pk_add_f32 v[22:23], v[22:23], v[102:103]
    v_pk_add_f32 v[122:123], v[122:123], v[142:143]
    v_pk_add_f32 v[22:23], v[22:23], v[122:123]
    v_pk_add_f32 v[24:25], v[24:25], v[104:105]
    v_pk_add_f32 v[124:125], v[124:125], v[144:145]
    v_pk_add_f32 v[24:25], v[24:25], v[124:125]
    v_pk_add_f32 v[26:27], v[26:27], v[106:107]
    v_pk_add_f32 v[126:127], v[126:127], v[146:147]
    v_pk_add_f32 v[26:27], v[26:27], v[126:127]
    v_pk_add_f32 v[28:29], v[28:29], v[108:109]
    v_pk_add_f32 v[128:129], v[128:129], v[148:149]
    v_pk_add_f32 v[28:29], v[28:29], v[128:129]
    v_pk_add_f32 v[30:31], v[30:31], v[110:111]
    v_pk_add_f32 v[130:131], v[130:131], v[150:151]
    v_pk_add_f32 v[30:31], v[30:31], v[130:131]
    v_pk_add_f32 v[32:33], v[32:33], v[112:113]
    v_pk_add_f32 v[132:133], v[132:133], v[152:153]
    v_pk_add_f32 v[32:33], v[32:33], v[132:133]
    v_pk_add_f32 v[34:35], v[34:35], v[114:115]
    v_pk_add_f32 v[134:135], v[134:135], v[154:155]
    v_pk_add_f32 v[34:35], v[34:35], v[134:135]
    v_cvt_pk_bf16_f32 v180, v16, v17
    v_lshlrev_b32 v16, 16, v180
    v_and_b32 v17, 0xffff0000, v180
    v_cvt_pk_bf16_f32 v181, v18, v19
    v_lshlrev_b32 v18, 16, v181
    v_and_b32 v19, 0xffff0000, v181
    v_mul_f32 v182, s90, v16
    v_mul_f32 v183, s90, v17
    v_exp_f32 v182, v182
    v_exp_f32 v183, v183
    v_add_f32 v182, 1.0, v182
    v_add_f32 v183, 1.0, v183
    v_rcp_f32 v182, v182
    v_rcp_f32 v183, v183
    v_mul_f32 v182, v16, v182
    v_mul_f32 v183, v17, v183
    v_cvt_pk_bf16_f32 v186, v182, v183
    v_mul_f32 v184, s90, v18
    v_mul_f32 v185, s90, v19
    v_exp_f32 v184, v184
    v_exp_f32 v185, v185
    v_add_f32 v184, 1.0, v184
    v_add_f32 v185, 1.0, v185
    v_rcp_f32 v184, v184
    v_rcp_f32 v185, v185
    v_mul_f32 v184, v18, v184
    v_mul_f32 v185, v19, v185
    v_cvt_pk_bf16_f32 v187, v184, v185
    v_lshlrev_b32 v16, 16, v186
    v_and_b32 v17, 0xffff0000, v186
    v_lshlrev_b32 v18, 16, v187
    v_and_b32 v19, 0xffff0000, v187
    v_cvt_pk_bf16_f32 v180, v20, v21
    v_lshlrev_b32 v20, 16, v180
    v_and_b32 v21, 0xffff0000, v180
    v_cvt_pk_bf16_f32 v181, v22, v23
    v_lshlrev_b32 v22, 16, v181
    v_and_b32 v23, 0xffff0000, v181
    v_mul_f32 v182, s90, v20
    v_mul_f32 v183, s90, v21
    v_exp_f32 v182, v182
    v_exp_f32 v183, v183
    v_add_f32 v182, 1.0, v182
    v_add_f32 v183, 1.0, v183
    v_rcp_f32 v182, v182
    v_rcp_f32 v183, v183
    v_mul_f32 v182, v20, v182
    v_mul_f32 v183, v21, v183
    v_cvt_pk_bf16_f32 v186, v182, v183
    v_mul_f32 v184, s90, v22
    v_mul_f32 v185, s90, v23
    v_exp_f32 v184, v184
    v_exp_f32 v185, v185
    v_add_f32 v184, 1.0, v184
    v_add_f32 v185, 1.0, v185
    v_rcp_f32 v184, v184
    v_rcp_f32 v185, v185
    v_mul_f32 v184, v22, v184
    v_mul_f32 v185, v23, v185
    v_cvt_pk_bf16_f32 v187, v184, v185
    v_lshlrev_b32 v20, 16, v186
    v_and_b32 v21, 0xffff0000, v186
    v_lshlrev_b32 v22, 16, v187
    v_and_b32 v23, 0xffff0000, v187
    v_cvt_pk_bf16_f32 v180, v24, v25
    v_lshlrev_b32 v24, 16, v180
    v_and_b32 v25, 0xffff0000, v180
    v_cvt_pk_bf16_f32 v181, v26, v27
    v_lshlrev_b32 v26, 16, v181
    v_and_b32 v27, 0xffff0000, v181
    v_mul_f32 v182, s90, v24
    v_mul_f32 v183, s90, v25
    v_exp_f32 v182, v182
    v_exp_f32 v183, v183
    v_add_f32 v182, 1.0, v182
    v_add_f32 v183, 1.0, v183
    v_rcp_f32 v182, v182
    v_rcp_f32 v183, v183
    v_mul_f32 v182, v24, v182
    v_mul_f32 v183, v25, v183
    v_cvt_pk_bf16_f32 v186, v182, v183
    v_mul_f32 v184, s90, v26
    v_mul_f32 v185, s90, v27
    v_exp_f32 v184, v184
    v_exp_f32 v185, v185
    v_add_f32 v184, 1.0, v184
    v_add_f32 v185, 1.0, v185
    v_rcp_f32 v184, v184
    v_rcp_f32 v185, v185
    v_mul_f32 v184, v26, v184
    v_mul_f32 v185, v27, v185
    v_cvt_pk_bf16_f32 v187, v184, v185
    v_lshlrev_b32 v24, 16, v186
    v_and_b32 v25, 0xffff0000, v186
    v_lshlrev_b32 v26, 16, v187
    v_and_b32 v27, 0xffff0000, v187
    v_cvt_pk_bf16_f32 v180, v28, v29
    v_lshlrev_b32 v28, 16, v180
    v_and_b32 v29, 0xffff0000, v180
    v_cvt_pk_bf16_f32 v181, v30, v31
    v_lshlrev_b32 v30, 16, v181
    v_and_b32 v31, 0xffff0000, v181
    v_mul_f32 v182, s90, v28
    v_mul_f32 v183, s90, v29
    v_exp_f32 v182, v182
    v_exp_f32 v183, v183
    v_add_f32 v182, 1.0, v182
    v_add_f32 v183, 1.0, v183
    v_rcp_f32 v182, v182
    v_rcp_f32 v183, v183
    v_mul_f32 v182, v28, v182
    v_mul_f32 v183, v29, v183
    v_cvt_pk_bf16_f32 v186, v182, v183
    v_mul_f32 v184, s90, v30
    v_mul_f32 v185, s90, v31
    v_exp_f32 v184, v184
    v_exp_f32 v185, v185
    v_add_f32 v184, 1.0, v184
    v_add_f32 v185, 1.0, v185
    v_rcp_f32 v184, v184
    v_rcp_f32 v185, v185
    v_mul_f32 v184, v30, v184
    v_mul_f32 v185, v31, v185
    v_cvt_pk_bf16_f32 v187, v184, v185
    v_lshlrev_b32 v28, 16, v186
    v_and_b32 v29, 0xffff0000, v186
    v_lshlrev_b32 v30, 16, v187
    v_and_b32 v31, 0xffff0000, v187
    v_cvt_pk_bf16_f32 v180, v32, v33
    v_lshlrev_b32 v32, 16, v180
    v_and_b32 v33, 0xffff0000, v180
    v_cvt_pk_bf16_f32 v181, v34, v35
    v_lshlrev_b32 v34, 16, v181
    v_and_b32 v35, 0xffff0000, v181
    v_mul_f32 v182, s90, v32
    v_mul_f32 v183, s90, v33
    v_exp_f32 v182, v182
    v_exp_f32 v183, v183
    v_add_f32 v182, 1.0, v182
    v_add_f32 v183, 1.0, v183
    v_rcp_f32 v182, v182
    v_rcp_f32 v183, v183
    v_mul_f32 v182, v32, v182
    v_mul_f32 v183, v33, v183
    v_cvt_pk_bf16_f32 v186, v182, v183
    v_mul_f32 v184, s90, v34
    v_mul_f32 v185, s90, v35
    v_exp_f32 v184, v184
    v_exp_f32 v185, v185
    v_add_f32 v184, 1.0, v184
    v_add_f32 v185, 1.0, v185
    v_rcp_f32 v184, v184
    v_rcp_f32 v185, v185
    v_mul_f32 v184, v34, v184
    v_mul_f32 v185, v35, v185
    v_cvt_pk_bf16_f32 v187, v184, v185
    v_lshlrev_b32 v32, 16, v186
    v_and_b32 v33, 0xffff0000, v186
    v_lshlrev_b32 v34, 16, v187
    v_and_b32 v35, 0xffff0000, v187
    s_mov_b32 s94, 0
F_SP13:
    ds_read_b32 v14, v13 offset:16
    s_waitcnt lgkmcnt(0)
    v_readfirstlane_b32 s48, v14
    s_cmp_ge_u32 s48, 1
    s_cbranch_scc1 F_SPD13
    s_sleep 1
    s_add_u32 s94, s94, 1
    s_cmp_lt_u32 s94, 0x400000
    s_cbranch_scc1 F_SP13
F_SPD13:
    ds_read_b64_tr_b16 v[170:171], v12 offset:0
    ds_read_b64_tr_b16 v[172:173], v12 offset:2048
    ds_read_b64_tr_b16 v[174:175], v12 offset:4096
    ds_read_b64_tr_b16 v[176:177], v12 offset:6144
    ds_read_b64_tr_b16 v[178:179], v12 offset:8192
    s_waitcnt lgkmcnt(4)
    v_lshlrev_b32 v192, 16, v170
    v_and_b32 v193, 0xffff0000, v170
    v_lshlrev_b32 v194, 16, v171
    v_and_b32 v195, 0xffff0000, v171
    v_pk_mul_f32 v[220:221], v[220:221], v[192:193]
    v_pk_mul_f32 v[222:223], v[222:223], v[194:195]
    v_cvt_pk_bf16_f32 v180, v220, v221
    v_lshlrev_b32 v220, 16, v180
    v_and_b32 v221, 0xffff0000, v180
    v_cvt_pk_bf16_f32 v181, v222, v223
    v_lshlrev_b32 v222, 16, v181
    v_and_b32 v223, 0xffff0000, v181
    v_pk_mul_f32 v[220:221], v[220:221], v[16:17]
    v_pk_mul_f32 v[222:223], v[222:223], v[18:19]
    v_cvt_pk_bf16_f32 v180, v220, v221
    v_lshlrev_b32 v220, 16, v180
    v_and_b32 v221, 0xffff0000, v180
    v_cvt_pk_bf16_f32 v181, v222, v223
    v_lshlrev_b32 v222, 16, v181
    v_and_b32 v223, 0xffff0000, v181
    v_pk_add_f32 v[220:221], v[220:221], v[200:201]
    v_pk_add_f32 v[222:223], v[222:223], v[202:203]
    v_cvt_pk_bf16_f32 v96, v220, v221
    v_cvt_pk_bf16_f32 v97, v222, v223
    s_waitcnt lgkmcnt(3)
    v_lshlrev_b32 v192, 16, v172
    v_and_b32 v193, 0xffff0000, v172
    v_lshlrev_b32 v194, 16, v173
    v_and_b32 v195, 0xffff0000, v173
    v_pk_mul_f32 v[224:225], v[224:225], v[192:193]
    v_pk_mul_f32 v[226:227], v[226:227], v[194:195]
    v_cvt_pk_bf16_f32 v180, v224, v225
    v_lshlrev_b32 v224, 16, v180
    v_and_b32 v225, 0xffff0000, v180
    v_cvt_pk_bf16_f32 v181, v226, v227
    v_lshlrev_b32 v226, 16, v181
    v_and_b32 v227, 0xffff0000, v181
    v_pk_mul_f32 v[224:225], v[224:225], v[20:21]
    v_pk_mul_f32 v[226:227], v[226:227], v[22:23]
    v_cvt_pk_bf16_f32 v180, v224, v225
    v_lshlrev_b32 v224, 16, v180
    v_and_b32 v225, 0xffff0000, v180
    v_cvt_pk_bf16_f32 v181, v226, v227
    v_lshlrev_b32 v226, 16, v181
    v_and_b32 v227, 0xffff0000, v181
    v_pk_add_f32 v[224:225], v[224:225], v[204:205]
    v_pk_add_f32 v[226:227], v[226:227], v[206:207]
    v_cvt_pk_bf16_f32 v98, v224, v225
    v_cvt_pk_bf16_f32 v99, v226, v227
    s_waitcnt lgkmcnt(2)
    v_lshlrev_b32 v192, 16, v174
    v_and_b32 v193, 0xffff0000, v174
    v_lshlrev_b32 v194, 16, v175
    v_and_b32 v195, 0xffff0000, v175
    v_pk_mul_f32 v[228:229], v[228:229], v[192:193]
    v_pk_mul_f32 v[230:231], v[230:231], v[194:195]
    v_cvt_pk_bf16_f32 v180, v228, v229
    v_lshlrev_b32 v228, 16, v180
    v_and_b32 v229, 0xffff0000, v180
    v_cvt_pk_bf16_f32 v181, v230, v231
    v_lshlrev_b32 v230, 16, v181
    v_and_b32 v231, 0xffff0000, v181
    v_pk_mul_f32 v[228:229], v[228:229], v[24:25]
    v_pk_mul_f32 v[230:231], v[230:231], v[26:27]
    v_cvt_pk_bf16_f32 v180, v228, v229
    v_lshlrev_b32 v228, 16, v180
    v_and_b32 v229, 0xffff0000, v180
    v_cvt_pk_bf16_f32 v181, v230, v231
    v_lshlrev_b32 v230, 16, v181
    v_and_b32 v231, 0xffff0000, v181
    v_pk_add_f32 v[228:229], v[228:229], v[208:209]
    v_pk_add_f32 v[230:231], v[230:231], v[210:211]
    v_cvt_pk_bf16_f32 v100, v228, v229
    v_cvt_pk_bf16_f32 v101, v230, v231
    s_waitcnt lgkmcnt(1)
    v_lshlrev_b32 v192, 16, v176
    v_and_b32 v193, 0xffff0000, v176
    v_lshlrev_b32 v194, 16, v177
    v_and_b32 v195, 0xffff0000, v177
    v_pk_mul_f32 v[232:233], v[232:233], v[192:193]
    v_pk_mul_f32 v[234:235], v[234:235], v[194:195]
    v_cvt_pk_bf16_f32 v180, v232, v233
    v_lshlrev_b32 v232, 16, v180
    v_and_b32 v233, 0xffff0000, v180
    v_cvt_pk_bf16_f32 v181, v234, v235
    v_lshlrev_b32 v234, 16, v181
    v_and_b32 v235, 0xffff0000, v181
    v_pk_mul_f32 v[232:233], v[232:233], v[28:29]
    v_pk_mul_f32 v[234:235], v[234:235], v[30:31]
    v_cvt_pk_bf16_f32 v180, v232, v233
    v_lshlrev_b32 v232, 16, v180
    v_and_b32 v233, 0xffff0000, v180
    v_cvt_pk_bf16_f32 v181, v234, v235
    v_lshlrev_b32 v234, 16, v181
    v_and_b32 v235, 0xffff0000, v181
    v_pk_add_f32 v[232:233], v[232:233], v[212:213]
    v_pk_add_f32 v[234:235], v[234:235], v[214:215]
    v_cvt_pk_bf16_f32 v102, v232, v233
    v_cvt_pk_bf16_f32 v103, v234, v235
    s_waitcnt lgkmcnt(0)
    v_lshlrev_b32 v192, 16, v178
    v_and_b32 v193, 0xffff0000, v178
    v_lshlrev_b32 v194, 16, v179
    v_and_b32 v195, 0xffff0000, v179
    v_pk_mul_f32 v[236:237], v[236:237], v[192:193]
    v_pk_mul_f32 v[238:239], v[238:239], v[194:195]
    v_cvt_pk_bf16_f32 v180, v236, v237
    v_lshlrev_b32 v236, 16, v180
    v_and_b32 v237, 0xffff0000, v180
    v_cvt_pk_bf16_f32 v181, v238, v239
    v_lshlrev_b32 v238, 16, v181
    v_and_b32 v239, 0xffff0000, v181
    v_pk_mul_f32 v[236:237], v[236:237], v[32:33]
    v_pk_mul_f32 v[238:239], v[238:239], v[34:35]
    v_cvt_pk_bf16_f32 v180, v236, v237
    v_lshlrev_b32 v236, 16, v180
    v_and_b32 v237, 0xffff0000, v180
    v_cvt_pk_bf16_f32 v181, v238, v239
    v_lshlrev_b32 v238, 16, v181
    v_and_b32 v239, 0xffff0000, v181
    v_pk_add_f32 v[236:237], v[236:237], v[216:217]
    v_pk_add_f32 v[238:239], v[238:239], v[218:219]
    v_cvt_pk_bf16_f32 v104, v236, v237
    v_cvt_pk_bf16_f32 v105, v238, v239
    ds_write_b64 v11, v[96:97] offset:0
    ds_write_b64 v11, v[98:99] offset:32
    ds_write_b64 v11, v[100:101] offset:64
    ds_write_b64 v11, v[102:103] offset:96
    ds_write_b64 v11, v[104:105] offset:128
    v_add_u32 v12, s55, v3
    s_waitcnt lgkmcnt(0)
    ds_read_b128 v[108:111], v12
    ds_read_b128 v[112:115], v12 offset:1024
    ds_read_b128 v[116:119], v12 offset:2048
    s_waitcnt lgkmcnt(2)
    buffer_store_dwordx4 v[108:111], v240, s[12:15], s54 offen
    s_waitcnt lgkmcnt(1)
    buffer_store_dwordx4 v[112:115], v241, s[12:15], s54 offen
    s_waitcnt lgkmcnt(0)
    buffer_store_dwordx4 v[116:119], v242, s[12:15], s54 offen
    s_endpgm
F_CONV:
    s_cmp_lt_i32 s100, 0
    s_cbranch_scc1 K1_END
    s_sub_u32 s37, s3, 4
    s_mul_i32 s37, s37, 21248
    s_and_b32 s49, s100, 0xfffffffe
    s_lshl_b32 s49, s49, 1
    s_add_u32 s50, s70, s49
    s_addc_u32 s51, s71, 0
    s_load_dword s52, s[50:51], 0
    v_lshlrev_b32 v3, 4, v2
    v_add_u32 v4, s37, v3
    v_mov_b32 v8, 0
    v_mov_b32 v9, 0
    v_mov_b32 v10, 0
    v_mov_b32 v11, 0
    v_cmp_gt_u32 vcc, 30, v2
    s_and_saveexec_b64 s[56:57], vcc
    ds_write_b128 v4, v[8:11] offset:20736
    s_mov_b64 exec, s[56:57]
    v_and_b32 v16, 15, v2
    v_lshrrev_b32 v17, 4, v2
    v_add_u32 v5, 1, v16
    v_and_b32 v5, 3, v5
    v_mul_u32_u24 v6, 4158, v5
    v_lshl_add_u32 v6, v16, 1, v6
    v_lshlrev_b32 v7, 4, v17
    v_sub_u32 v6, v6, v7
    v_add_u32 v6, 50, v6
    v_add_u32 v6, s37, v6
    v_lshlrev_b32 v12, 5, v16
    v_add_u32 v12, v12, v7
    v_sub_u32 v12, 17168, v12
    v_add_u32 v12, s37, v12
    v_lshlrev_b32 v13, 5, v16
    v_lshl_add_u32 v13, v17, 3, v13
    v_sub_u32 v14, 17144, v13
    v_add_u32 v14, s37, v14
    v_add_u32 v13, s37, v13
    v_lshrrev_b32 v15, 3, v2
    v_mul_u32_u24 v15, 4160, v15
    v_and_b32 v18, 7, v2
    v_lshl_add_u32 v15, v18, 2, v15
    v_add_u32 v15, s37, v15
    s_cmp_eq_u32 s35, 1
    s_cbranch_scc1 F_KFOK
    s_waitcnt vmcnt(0)
F_KFOK:
    v_readfirstlane_b32 s53, v180
    s_nop 0
    v_readfirstlane_b32 s54, v181
    v_mov_b32 v19, 0
    s_lshl_b32 s55, s53, 16
    s_lshr_b32 s58, s53, 16
    s_lshl_b32 s54, s54, 16
    s_or_b32 s58, s58, s54
    v_writelane_b32 v19, s55, 15
    v_writelane_b32 v19, s53, 23
    v_writelane_b32 v19, s55, 30
    v_writelane_b32 v19, s58, 31
    v_cmp_gt_u32 vcc, 32, v2
    s_and_saveexec_b64 s[56:57], vcc
    ds_write_b32 v15, v19
    s_mov_b64 exec, s[56:57]
    ds_write_b128 v4, v[180:183] offset:32
    ds_write_b128 v4, v[184:187] offset:8352
    v_alignbit_b32 v88, v184, v180, 16
    v_alignbit_b32 v92, v188, v184, 16
    v_alignbit_b32 v89, v185, v181, 16
    v_alignbit_b32 v93, v189, v185, 16
    v_alignbit_b32 v90, v186, v182, 16
    v_alignbit_b32 v94, v190, v186, 16
    v_alignbit_b32 v91, v187, v183, 16
    v_alignbit_b32 v95, v191, v187, 16
    ds_write_b128 v4, v[88:91] offset:4192
    ds_write_b128 v4, v[92:95] offset:12512
    ds_write_b128 v4, v[192:195] offset:1056
    ds_write_b128 v4, v[196:199] offset:9376
    v_alignbit_b32 v96, v196, v192, 16
    v_alignbit_b32 v100, v200, v196, 16
    v_alignbit_b32 v97, v197, v193, 16
    v_alignbit_b32 v101, v201, v197, 16
    v_alignbit_b32 v98, v198, v194, 16
    v_alignbit_b32 v102, v202, v198, 16
    v_alignbit_b32 v99, v199, v195, 16
    v_alignbit_b32 v103, v203, v199, 16
    ds_write_b128 v4, v[96:99] offset:5216
    ds_write_b128 v4, v[100:103] offset:13536
    ds_write_b128 v4, v[204:207] offset:2080
    ds_write_b128 v4, v[208:211] offset:10400
    v_alignbit_b32 v88, v208, v204, 16
    v_alignbit_b32 v92, v212, v208, 16
    v_alignbit_b32 v89, v209, v205, 16
    v_alignbit_b32 v93, v213, v209, 16
    v_alignbit_b32 v90, v210, v206, 16
    v_alignbit_b32 v94, v214, v210, 16
    v_alignbit_b32 v91, v211, v207, 16
    v_alignbit_b32 v95, v215, v211, 16
    ds_write_b128 v4, v[88:91] offset:6240
    ds_write_b128 v4, v[92:95] offset:14560
    ds_write_b128 v4, v[216:219] offset:3104
    ds_write_b128 v4, v[220:223] offset:11424
    v_alignbit_b32 v96, v220, v216, 16
    v_alignbit_b32 v100, v224, v220, 16
    v_alignbit_b32 v97, v221, v217, 16
    v_alignbit_b32 v101, v225, v221, 16
    v_alignbit_b32 v98, v222, v218, 16
    v_alignbit_b32 v102, v226, v222, 16
    v_alignbit_b32 v99, v223, v219, 16
    v_alignbit_b32 v103, v227, v223, 16
    ds_write_b128 v4, v[96:99] offset:7264
    ds_write_b128 v4, v[100:103] offset:15584
    v_mov_b32 v20, 0
    v_mov_b32 v21, 0
    v_mov_b32 v22, 0
    v_mov_b32 v23, 0
    v_mov_b32 v24, 0
    v_mov_b32 v25, 0
    v_mov_b32 v26, 0
    v_mov_b32 v27, 0
    v_mov_b32 v28, 0
    v_mov_b32 v29, 0
    v_mov_b32 v30, 0
    v_mov_b32 v31, 0
    v_mov_b32 v32, 0
    v_mov_b32 v33, 0
    v_mov_b32 v34, 0
    v_mov_b32 v35, 0
    v_mov_b32 v36, 0
    v_mov_b32 v37, 0
    v_mov_b32 v38, 0
    v_mov_b32 v39, 0
    v_mov_b32 v40, 0
    v_mov_b32 v41, 0
    v_mov_b32 v42, 0
    v_mov_b32 v43, 0
    v_mov_b32 v44, 0
    v_mov_b32 v45, 0
    v_mov_b32 v46, 0
    v_mov_b32 v47, 0
    v_mov_b32 v48, 0
    v_mov_b32 v49, 0
    v_mov_b32 v50, 0
    v_mov_b32 v51, 0
    s_cmp_eq_u32 s35, 1
    s_cbranch_scc1 F_KVFAST
    s_cmp_ge_u32 s5, 28
    s_cbranch_scc1 F_NOHA1
    v_mov_b32 v180, 160256
    v_mov_b32 v181, 1
    s_and_b32 s48, s6, 1
    s_lshl_b32 s48, s48, 4
    v_add_u32 v183, s48, v2
    v_lshlrev_b32 v183, 3, v183
    s_lshr_b32 s48, s6, 1
    v_add_u32 v183, s48, v183
    v_lshlrev_b32 v183, 7, v183
    s_lshl_b32 s48, s7, 2
    s_add_u32 s48, s48, 16990240
    v_add_u32 v183, s48, v183
    s_waitcnt vmcnt(0)
    s_mov_b64 exec, 1
    ds_add_rtn_u32 v182, v180, v181
    s_mov_b64 exec, -1
    s_waitcnt lgkmcnt(0)
    v_readfirstlane_b32 s48, v182
    s_cmp_lg_u32 s48, 7
    s_cbranch_scc1 F_HA14
    s_mov_b32 exec_lo, 0xffff
    s_mov_b32 exec_hi, 0
    buffer_store_dword v181, v183, s[28:31], 0 offen sc1
    s_mov_b64 exec, -1
F_HA14:
F_NOHA1:
    v_mov_b32 v18, 160256
    s_mov_b32 s94, 0
F_SP15:
    ds_read_b32 v19, v18 offset:8
    s_waitcnt lgkmcnt(0)
    v_readfirstlane_b32 s48, v19
    s_cmp_ge_u32 s48, 1
    s_cbranch_scc1 F_SPD15
    s_sleep 1
    s_add_u32 s94, s94, 1
    s_cmp_lt_u32 s94, 0x400000
    s_cbranch_scc1 F_SP15
F_SPD15:
    s_add_u32 s49, s101, 7340032
    s_add_u32 m0, s37, 16640
    s_nop 0
    buffer_load_dwordx4 v3, s[28:31], s49 offen offset:0 sc1 lds
    buffer_load_dwordx4 v3, s[28:31], s49 offen offset:1024 sc1 lds
    buffer_load_dwordx4 v3, s[28:31], s49 offen offset:2048 sc1 lds
    buffer_load_dwordx4 v3, s[28:31], s49 offen offset:3072 sc1 lds
    s_waitcnt vmcnt(0)
F_KVFAST:
    s_waitcnt vmcnt(4) lgkmcnt(0)
    s_setprio 1
    ds_read_b128 v[84:87], v12 offset:3584
    ds_read_b64 v[52:53], v6 offset:0
    ds_read_b64 v[54:55], v6 offset:8
    ds_read_b128 v[88:91], v12 offset:3072
    ds_read_b64 v[56:57], v6 offset:512
    ds_read_b64 v[58:59], v6 offset:520
    ds_read_b128 v[92:95], v12 offset:2560
    ds_read_b64 v[60:61], v6 offset:1024
    ds_read_b64 v[62:63], v6 offset:1032
    ds_read_b128 v[96:99], v12 offset:2048
    ds_read_b64 v[64:65], v6 offset:1536
    ds_read_b64 v[66:67], v6 offset:1544
    ds_read_b128 v[100:103], v12 offset:1536
    ds_read_b64 v[68:69], v6 offset:2048
    ds_read_b64 v[70:71], v6 offset:2056
    ds_read_b128 v[104:107], v12 offset:1024
    ds_read_b64 v[72:73], v6 offset:2560
    ds_read_b64 v[74:75], v6 offset:2568
    ds_read_b128 v[108:111], v12 offset:512
    ds_read_b64 v[76:77], v6 offset:3072
    ds_read_b64 v[78:79], v6 offset:3080
    ds_read_b128 v[112:115], v12 offset:0
    ds_read_b64 v[80:81], v6 offset:3584
    ds_read_b64 v[82:83], v6 offset:3592
    s_cmp_lg_u32 s35, 1
    s_cbranch_scc1 F_NOHA2
    v_mov_b32 v180, 160256
    v_mov_b32 v181, 1
    s_and_b32 s48, s6, 1
    s_lshl_b32 s48, s48, 4
    v_add_u32 v183, s48, v2
    v_lshlrev_b32 v183, 3, v183
    s_lshr_b32 s48, s6, 1
    v_add_u32 v183, s48, v183
    v_lshlrev_b32 v183, 7, v183
    s_lshl_b32 s48, s7, 2
    s_add_u32 s48, s48, 16990240
    v_add_u32 v183, s48, v183
    s_waitcnt vmcnt(0)
    s_mov_b64 exec, 1
    ds_add_rtn_u32 v182, v180, v181
    s_mov_b64 exec, -1
    s_waitcnt lgkmcnt(0)
    v_readfirstlane_b32 s48, v182
    s_cmp_lg_u32 s48, 7
    s_cbranch_scc1 F_HA16
    s_mov_b32 exec_lo, 0xffff
    s_mov_b32 exec_hi, 0
    buffer_store_dword v181, v183, s[28:31], 0 offen sc1
    s_mov_b64 exec, -1
F_HA16:
F_NOHA2:
    s_waitcnt lgkmcnt(0)
    v_mfma_f32_16x16x32_bf16 v[20:23], v[52:55], v[84:87], v[20:23]
    ds_read_b128 v[148:151], v12 offset:3648
    v_mfma_f32_16x16x32_bf16 v[24:27], v[52:55], v[88:91], v[24:27]
    ds_read_b64 v[116:117], v6 offset:64
    v_mfma_f32_16x16x32_bf16 v[28:31], v[52:55], v[92:95], v[28:31]
    v_mfma_f32_16x16x32_bf16 v[32:35], v[52:55], v[96:99], v[32:35]
    ds_read_b64 v[118:119], v6 offset:72
    v_mfma_f32_16x16x32_bf16 v[36:39], v[52:55], v[100:103], v[36:39]
    ds_read_b128 v[152:155], v12 offset:3136
    v_mfma_f32_16x16x32_bf16 v[40:43], v[52:55], v[104:107], v[40:43]
    v_mfma_f32_16x16x32_bf16 v[44:47], v[52:55], v[108:111], v[44:47]
    ds_read_b64 v[120:121], v6 offset:576
    v_mfma_f32_16x16x32_bf16 v[48:51], v[52:55], v[112:115], v[48:51]
    ds_read_b64 v[122:123], v6 offset:584
    v_mfma_f32_16x16x32_bf16 v[24:27], v[56:59], v[84:87], v[24:27]
    v_mfma_f32_16x16x32_bf16 v[28:31], v[56:59], v[88:91], v[28:31]
    ds_read_b128 v[156:159], v12 offset:2624
    v_mfma_f32_16x16x32_bf16 v[32:35], v[56:59], v[92:95], v[32:35]
    ds_read_b64 v[124:125], v6 offset:1088
    v_mfma_f32_16x16x32_bf16 v[36:39], v[56:59], v[96:99], v[36:39]
    v_mfma_f32_16x16x32_bf16 v[40:43], v[56:59], v[100:103], v[40:43]
    ds_read_b64 v[126:127], v6 offset:1096
    v_mfma_f32_16x16x32_bf16 v[44:47], v[56:59], v[104:107], v[44:47]
    ds_read_b128 v[160:163], v12 offset:2112
    v_mfma_f32_16x16x32_bf16 v[48:51], v[56:59], v[108:111], v[48:51]
    v_mfma_f32_16x16x32_bf16 v[28:31], v[60:63], v[84:87], v[28:31]
    ds_read_b64 v[128:129], v6 offset:1600
    v_mfma_f32_16x16x32_bf16 v[32:35], v[60:63], v[88:91], v[32:35]
    ds_read_b64 v[130:131], v6 offset:1608
    v_mfma_f32_16x16x32_bf16 v[36:39], v[60:63], v[92:95], v[36:39]
    v_mfma_f32_16x16x32_bf16 v[40:43], v[60:63], v[96:99], v[40:43]
    ds_read_b128 v[164:167], v12 offset:1600
    v_mfma_f32_16x16x32_bf16 v[44:47], v[60:63], v[100:103], v[44:47]
    ds_read_b64 v[132:133], v6 offset:2112
    v_mfma_f32_16x16x32_bf16 v[48:51], v[60:63], v[104:107], v[48:51]
    v_mfma_f32_16x16x32_bf16 v[32:35], v[64:67], v[84:87], v[32:35]
    ds_read_b64 v[134:135], v6 offset:2120
    v_mfma_f32_16x16x32_bf16 v[36:39], v[64:67], v[88:91], v[36:39]
    ds_read_b128 v[168:171], v12 offset:1088
    v_mfma_f32_16x16x32_bf16 v[40:43], v[64:67], v[92:95], v[40:43]
    v_mfma_f32_16x16x32_bf16 v[44:47], v[64:67], v[96:99], v[44:47]
    ds_read_b64 v[136:137], v6 offset:2624
    v_mfma_f32_16x16x32_bf16 v[48:51], v[64:67], v[100:103], v[48:51]
    ds_read_b64 v[138:139], v6 offset:2632
    v_mfma_f32_16x16x32_bf16 v[36:39], v[68:71], v[84:87], v[36:39]
    v_mfma_f32_16x16x32_bf16 v[40:43], v[68:71], v[88:91], v[40:43]
    ds_read_b128 v[172:175], v12 offset:576
    v_mfma_f32_16x16x32_bf16 v[44:47], v[68:71], v[92:95], v[44:47]
    ds_read_b64 v[140:141], v6 offset:3136
    v_mfma_f32_16x16x32_bf16 v[48:51], v[68:71], v[96:99], v[48:51]
    v_mfma_f32_16x16x32_bf16 v[40:43], v[72:75], v[84:87], v[40:43]
    ds_read_b64 v[142:143], v6 offset:3144
    v_mfma_f32_16x16x32_bf16 v[44:47], v[72:75], v[88:91], v[44:47]
    ds_read_b128 v[176:179], v12 offset:64
    v_mfma_f32_16x16x32_bf16 v[48:51], v[72:75], v[92:95], v[48:51]
    v_mfma_f32_16x16x32_bf16 v[44:47], v[76:79], v[84:87], v[44:47]
    ds_read_b64 v[144:145], v6 offset:3648
    v_mfma_f32_16x16x32_bf16 v[48:51], v[76:79], v[88:91], v[48:51]
    ds_read_b64 v[146:147], v6 offset:3656
    v_mfma_f32_16x16x32_bf16 v[48:51], v[80:83], v[84:87], v[48:51]
    s_waitcnt lgkmcnt(0)
    v_mfma_f32_16x16x32_bf16 v[20:23], v[116:119], v[148:151], v[20:23]
    ds_read_b128 v[84:87], v12 offset:3712
    v_mfma_f32_16x16x32_bf16 v[24:27], v[116:119], v[152:155], v[24:27]
    ds_read_b64 v[52:53], v6 offset:128
    v_mfma_f32_16x16x32_bf16 v[28:31], v[116:119], v[156:159], v[28:31]
    v_mfma_f32_16x16x32_bf16 v[32:35], v[116:119], v[160:163], v[32:35]
    ds_read_b64 v[54:55], v6 offset:136
    v_mfma_f32_16x16x32_bf16 v[36:39], v[116:119], v[164:167], v[36:39]
    ds_read_b128 v[88:91], v12 offset:3200
    v_mfma_f32_16x16x32_bf16 v[40:43], v[116:119], v[168:171], v[40:43]
    v_mfma_f32_16x16x32_bf16 v[44:47], v[116:119], v[172:175], v[44:47]
    ds_read_b64 v[56:57], v6 offset:640
    v_mfma_f32_16x16x32_bf16 v[48:51], v[116:119], v[176:179], v[48:51]
    ds_read_b64 v[58:59], v6 offset:648
    v_mfma_f32_16x16x32_bf16 v[24:27], v[120:123], v[148:151], v[24:27]
    v_mfma_f32_16x16x32_bf16 v[28:31], v[120:123], v[152:155], v[28:31]
    ds_read_b128 v[92:95], v12 offset:2688
    v_mfma_f32_16x16x32_bf16 v[32:35], v[120:123], v[156:159], v[32:35]
    ds_read_b64 v[60:61], v6 offset:1152
    v_mfma_f32_16x16x32_bf16 v[36:39], v[120:123], v[160:163], v[36:39]
    v_mfma_f32_16x16x32_bf16 v[40:43], v[120:123], v[164:167], v[40:43]
    ds_read_b64 v[62:63], v6 offset:1160
    v_mfma_f32_16x16x32_bf16 v[44:47], v[120:123], v[168:171], v[44:47]
    ds_read_b128 v[96:99], v12 offset:2176
    v_mfma_f32_16x16x32_bf16 v[48:51], v[120:123], v[172:175], v[48:51]
    v_mfma_f32_16x16x32_bf16 v[28:31], v[124:127], v[148:151], v[28:31]
    ds_read_b64 v[64:65], v6 offset:1664
    v_mfma_f32_16x16x32_bf16 v[32:35], v[124:127], v[152:155], v[32:35]
    ds_read_b64 v[66:67], v6 offset:1672
    v_mfma_f32_16x16x32_bf16 v[36:39], v[124:127], v[156:159], v[36:39]
    v_mfma_f32_16x16x32_bf16 v[40:43], v[124:127], v[160:163], v[40:43]
    ds_read_b128 v[100:103], v12 offset:1664
    v_mfma_f32_16x16x32_bf16 v[44:47], v[124:127], v[164:167], v[44:47]
    ds_read_b64 v[68:69], v6 offset:2176
    v_mfma_f32_16x16x32_bf16 v[48:51], v[124:127], v[168:171], v[48:51]
    v_mfma_f32_16x16x32_bf16 v[32:35], v[128:131], v[148:151], v[32:35]
    ds_read_b64 v[70:71], v6 offset:2184
    v_mfma_f32_16x16x32_bf16 v[36:39], v[128:131], v[152:155], v[36:39]
    ds_read_b128 v[104:107], v12 offset:1152
    v_mfma_f32_16x16x32_bf16 v[40:43], v[128:131], v[156:159], v[40:43]
    v_mfma_f32_16x16x32_bf16 v[44:47], v[128:131], v[160:163], v[44:47]
    ds_read_b64 v[72:73], v6 offset:2688
    v_mfma_f32_16x16x32_bf16 v[48:51], v[128:131], v[164:167], v[48:51]
    ds_read_b64 v[74:75], v6 offset:2696
    v_mfma_f32_16x16x32_bf16 v[36:39], v[132:135], v[148:151], v[36:39]
    v_mfma_f32_16x16x32_bf16 v[40:43], v[132:135], v[152:155], v[40:43]
    ds_read_b128 v[108:111], v12 offset:640
    v_mfma_f32_16x16x32_bf16 v[44:47], v[132:135], v[156:159], v[44:47]
    ds_read_b64 v[76:77], v6 offset:3200
    v_mfma_f32_16x16x32_bf16 v[48:51], v[132:135], v[160:163], v[48:51]
    v_mfma_f32_16x16x32_bf16 v[40:43], v[136:139], v[148:151], v[40:43]
    ds_read_b64 v[78:79], v6 offset:3208
    v_mfma_f32_16x16x32_bf16 v[44:47], v[136:139], v[152:155], v[44:47]
    ds_read_b128 v[112:115], v12 offset:128
    v_mfma_f32_16x16x32_bf16 v[48:51], v[136:139], v[156:159], v[48:51]
    v_mfma_f32_16x16x32_bf16 v[44:47], v[140:143], v[148:151], v[44:47]
    ds_read_b64 v[80:81], v6 offset:3712
    v_mfma_f32_16x16x32_bf16 v[48:51], v[140:143], v[152:155], v[48:51]
    ds_read_b64 v[82:83], v6 offset:3720
    v_mfma_f32_16x16x32_bf16 v[48:51], v[144:147], v[148:151], v[48:51]
    s_waitcnt lgkmcnt(0)
    v_mfma_f32_16x16x32_bf16 v[20:23], v[52:55], v[84:87], v[20:23]
    ds_read_b128 v[148:151], v12 offset:3776
    v_mfma_f32_16x16x32_bf16 v[24:27], v[52:55], v[88:91], v[24:27]
    ds_read_b64 v[116:117], v6 offset:192
    v_mfma_f32_16x16x32_bf16 v[28:31], v[52:55], v[92:95], v[28:31]
    v_mfma_f32_16x16x32_bf16 v[32:35], v[52:55], v[96:99], v[32:35]
    ds_read_b64 v[118:119], v6 offset:200
    v_mfma_f32_16x16x32_bf16 v[36:39], v[52:55], v[100:103], v[36:39]
    ds_read_b128 v[152:155], v12 offset:3264
    v_mfma_f32_16x16x32_bf16 v[40:43], v[52:55], v[104:107], v[40:43]
    v_mfma_f32_16x16x32_bf16 v[44:47], v[52:55], v[108:111], v[44:47]
    ds_read_b64 v[120:121], v6 offset:704
    v_mfma_f32_16x16x32_bf16 v[48:51], v[52:55], v[112:115], v[48:51]
    ds_read_b64 v[122:123], v6 offset:712
    v_mfma_f32_16x16x32_bf16 v[24:27], v[56:59], v[84:87], v[24:27]
    v_mfma_f32_16x16x32_bf16 v[28:31], v[56:59], v[88:91], v[28:31]
    ds_read_b128 v[156:159], v12 offset:2752
    v_mfma_f32_16x16x32_bf16 v[32:35], v[56:59], v[92:95], v[32:35]
    ds_read_b64 v[124:125], v6 offset:1216
    v_mfma_f32_16x16x32_bf16 v[36:39], v[56:59], v[96:99], v[36:39]
    v_mfma_f32_16x16x32_bf16 v[40:43], v[56:59], v[100:103], v[40:43]
    ds_read_b64 v[126:127], v6 offset:1224
    v_mfma_f32_16x16x32_bf16 v[44:47], v[56:59], v[104:107], v[44:47]
    ds_read_b128 v[160:163], v12 offset:2240
    v_mfma_f32_16x16x32_bf16 v[48:51], v[56:59], v[108:111], v[48:51]
    v_mfma_f32_16x16x32_bf16 v[28:31], v[60:63], v[84:87], v[28:31]
    ds_read_b64 v[128:129], v6 offset:1728
    v_mfma_f32_16x16x32_bf16 v[32:35], v[60:63], v[88:91], v[32:35]
    ds_read_b64 v[130:131], v6 offset:1736
    v_mfma_f32_16x16x32_bf16 v[36:39], v[60:63], v[92:95], v[36:39]
    v_mfma_f32_16x16x32_bf16 v[40:43], v[60:63], v[96:99], v[40:43]
    ds_read_b128 v[164:167], v12 offset:1728
    v_mfma_f32_16x16x32_bf16 v[44:47], v[60:63], v[100:103], v[44:47]
    ds_read_b64 v[132:133], v6 offset:2240
    v_mfma_f32_16x16x32_bf16 v[48:51], v[60:63], v[104:107], v[48:51]
    v_mfma_f32_16x16x32_bf16 v[32:35], v[64:67], v[84:87], v[32:35]
    ds_read_b64 v[134:135], v6 offset:2248
    v_mfma_f32_16x16x32_bf16 v[36:39], v[64:67], v[88:91], v[36:39]
    ds_read_b128 v[168:171], v12 offset:1216
    v_mfma_f32_16x16x32_bf16 v[40:43], v[64:67], v[92:95], v[40:43]
    v_mfma_f32_16x16x32_bf16 v[44:47], v[64:67], v[96:99], v[44:47]
    ds_read_b64 v[136:137], v6 offset:2752
    v_mfma_f32_16x16x32_bf16 v[48:51], v[64:67], v[100:103], v[48:51]
    ds_read_b64 v[138:139], v6 offset:2760
    v_mfma_f32_16x16x32_bf16 v[36:39], v[68:71], v[84:87], v[36:39]
    v_mfma_f32_16x16x32_bf16 v[40:43], v[68:71], v[88:91], v[40:43]
    ds_read_b128 v[172:175], v12 offset:704
    v_mfma_f32_16x16x32_bf16 v[44:47], v[68:71], v[92:95], v[44:47]
    ds_read_b64 v[140:141], v6 offset:3264
    v_mfma_f32_16x16x32_bf16 v[48:51], v[68:71], v[96:99], v[48:51]
    v_mfma_f32_16x16x32_bf16 v[40:43], v[72:75], v[84:87], v[40:43]
    ds_read_b64 v[142:143], v6 offset:3272
    v_mfma_f32_16x16x32_bf16 v[44:47], v[72:75], v[88:91], v[44:47]
    ds_read_b128 v[176:179], v12 offset:192
    v_mfma_f32_16x16x32_bf16 v[48:51], v[72:75], v[92:95], v[48:51]
    v_mfma_f32_16x16x32_bf16 v[44:47], v[76:79], v[84:87], v[44:47]
    ds_read_b64 v[144:145], v6 offset:3776
    v_mfma_f32_16x16x32_bf16 v[48:51], v[76:79], v[88:91], v[48:51]
    ds_read_b64 v[146:147], v6 offset:3784
    v_mfma_f32_16x16x32_bf16 v[48:51], v[80:83], v[84:87], v[48:51]
    s_waitcnt lgkmcnt(0)
    v_mfma_f32_16x16x32_bf16 v[20:23], v[116:119], v[148:151], v[20:23]
    ds_read_b128 v[84:87], v12 offset:3840
    v_mfma_f32_16x16x32_bf16 v[24:27], v[116:119], v[152:155], v[24:27]
    ds_read_b64 v[52:53], v6 offset:256
    v_mfma_f32_16x16x32_bf16 v[28:31], v[116:119], v[156:159], v[28:31]
    v_mfma_f32_16x16x32_bf16 v[32:35], v[116:119], v[160:163], v[32:35]
    ds_read_b64 v[54:55], v6 offset:264
    v_mfma_f32_16x16x32_bf16 v[36:39], v[116:119], v[164:167], v[36:39]
    ds_read_b128 v[88:91], v12 offset:3328
    v_mfma_f32_16x16x32_bf16 v[40:43], v[116:119], v[168:171], v[40:43]
    v_mfma_f32_16x16x32_bf16 v[44:47], v[116:119], v[172:175], v[44:47]
    ds_read_b64 v[56:57], v6 offset:768
    v_mfma_f32_16x16x32_bf16 v[48:51], v[116:119], v[176:179], v[48:51]
    ds_read_b64 v[58:59], v6 offset:776
    v_mfma_f32_16x16x32_bf16 v[24:27], v[120:123], v[148:151], v[24:27]
    v_mfma_f32_16x16x32_bf16 v[28:31], v[120:123], v[152:155], v[28:31]
    ds_read_b128 v[92:95], v12 offset:2816
    v_mfma_f32_16x16x32_bf16 v[32:35], v[120:123], v[156:159], v[32:35]
    ds_read_b64 v[60:61], v6 offset:1280
    v_mfma_f32_16x16x32_bf16 v[36:39], v[120:123], v[160:163], v[36:39]
    v_mfma_f32_16x16x32_bf16 v[40:43], v[120:123], v[164:167], v[40:43]
    ds_read_b64 v[62:63], v6 offset:1288
    v_mfma_f32_16x16x32_bf16 v[44:47], v[120:123], v[168:171], v[44:47]
    ds_read_b128 v[96:99], v12 offset:2304
    v_mfma_f32_16x16x32_bf16 v[48:51], v[120:123], v[172:175], v[48:51]
    v_mfma_f32_16x16x32_bf16 v[28:31], v[124:127], v[148:151], v[28:31]
    ds_read_b64 v[64:65], v6 offset:1792
    v_mfma_f32_16x16x32_bf16 v[32:35], v[124:127], v[152:155], v[32:35]
    ds_read_b64 v[66:67], v6 offset:1800
    v_mfma_f32_16x16x32_bf16 v[36:39], v[124:127], v[156:159], v[36:39]
    v_mfma_f32_16x16x32_bf16 v[40:43], v[124:127], v[160:163], v[40:43]
    ds_read_b128 v[100:103], v12 offset:1792
    v_mfma_f32_16x16x32_bf16 v[44:47], v[124:127], v[164:167], v[44:47]
    ds_read_b64 v[68:69], v6 offset:2304
    v_mfma_f32_16x16x32_bf16 v[48:51], v[124:127], v[168:171], v[48:51]
    v_mfma_f32_16x16x32_bf16 v[32:35], v[128:131], v[148:151], v[32:35]
    ds_read_b64 v[70:71], v6 offset:2312
    v_mfma_f32_16x16x32_bf16 v[36:39], v[128:131], v[152:155], v[36:39]
    ds_read_b128 v[104:107], v12 offset:1280
    v_mfma_f32_16x16x32_bf16 v[40:43], v[128:131], v[156:159], v[40:43]
    v_mfma_f32_16x16x32_bf16 v[44:47], v[128:131], v[160:163], v[44:47]
    ds_read_b64 v[72:73], v6 offset:2816
    v_mfma_f32_16x16x32_bf16 v[48:51], v[128:131], v[164:167], v[48:51]
    ds_read_b64 v[74:75], v6 offset:2824
    v_mfma_f32_16x16x32_bf16 v[36:39], v[132:135], v[148:151], v[36:39]
    v_mfma_f32_16x16x32_bf16 v[40:43], v[132:135], v[152:155], v[40:43]
    ds_read_b128 v[108:111], v12 offset:768
    v_mfma_f32_16x16x32_bf16 v[44:47], v[132:135], v[156:159], v[44:47]
    ds_read_b64 v[76:77], v6 offset:3328
    v_mfma_f32_16x16x32_bf16 v[48:51], v[132:135], v[160:163], v[48:51]
    v_mfma_f32_16x16x32_bf16 v[40:43], v[136:139], v[148:151], v[40:43]
    ds_read_b64 v[78:79], v6 offset:3336
    v_mfma_f32_16x16x32_bf16 v[44:47], v[136:139], v[152:155], v[44:47]
    ds_read_b128 v[112:115], v12 offset:256
    v_mfma_f32_16x16x32_bf16 v[48:51], v[136:139], v[156:159], v[48:51]
    v_mfma_f32_16x16x32_bf16 v[44:47], v[140:143], v[148:151], v[44:47]
    ds_read_b64 v[80:81], v6 offset:3840
    v_mfma_f32_16x16x32_bf16 v[48:51], v[140:143], v[152:155], v[48:51]
    ds_read_b64 v[82:83], v6 offset:3848
    v_mfma_f32_16x16x32_bf16 v[48:51], v[144:147], v[148:151], v[48:51]
    s_waitcnt lgkmcnt(0)
    v_mfma_f32_16x16x32_bf16 v[20:23], v[52:55], v[84:87], v[20:23]
    ds_read_b128 v[148:151], v12 offset:3904
    v_mfma_f32_16x16x32_bf16 v[24:27], v[52:55], v[88:91], v[24:27]
    ds_read_b64 v[116:117], v6 offset:320
    v_mfma_f32_16x16x32_bf16 v[28:31], v[52:55], v[92:95], v[28:31]
    v_mfma_f32_16x16x32_bf16 v[32:35], v[52:55], v[96:99], v[32:35]
    ds_read_b64 v[118:119], v6 offset:328
    v_mfma_f32_16x16x32_bf16 v[36:39], v[52:55], v[100:103], v[36:39]
    ds_read_b128 v[152:155], v12 offset:3392
    v_mfma_f32_16x16x32_bf16 v[40:43], v[52:55], v[104:107], v[40:43]
    v_mfma_f32_16x16x32_bf16 v[44:47], v[52:55], v[108:111], v[44:47]
    ds_read_b64 v[120:121], v6 offset:832
    v_mfma_f32_16x16x32_bf16 v[48:51], v[52:55], v[112:115], v[48:51]
    ds_read_b64 v[122:123], v6 offset:840
    v_mfma_f32_16x16x32_bf16 v[24:27], v[56:59], v[84:87], v[24:27]
    v_mfma_f32_16x16x32_bf16 v[28:31], v[56:59], v[88:91], v[28:31]
    ds_read_b128 v[156:159], v12 offset:2880
    v_mfma_f32_16x16x32_bf16 v[32:35], v[56:59], v[92:95], v[32:35]
    ds_read_b64 v[124:125], v6 offset:1344
    v_mfma_f32_16x16x32_bf16 v[36:39], v[56:59], v[96:99], v[36:39]
    v_mfma_f32_16x16x32_bf16 v[40:43], v[56:59], v[100:103], v[40:43]
    ds_read_b64 v[126:127], v6 offset:1352
    v_mfma_f32_16x16x32_bf16 v[44:47], v[56:59], v[104:107], v[44:47]
    ds_read_b128 v[160:163], v12 offset:2368
    v_mfma_f32_16x16x32_bf16 v[48:51], v[56:59], v[108:111], v[48:51]
    v_mfma_f32_16x16x32_bf16 v[28:31], v[60:63], v[84:87], v[28:31]
    ds_read_b64 v[128:129], v6 offset:1856
    v_mfma_f32_16x16x32_bf16 v[32:35], v[60:63], v[88:91], v[32:35]
    ds_read_b64 v[130:131], v6 offset:1864
    v_mfma_f32_16x16x32_bf16 v[36:39], v[60:63], v[92:95], v[36:39]
    v_mfma_f32_16x16x32_bf16 v[40:43], v[60:63], v[96:99], v[40:43]
    ds_read_b128 v[164:167], v12 offset:1856
    v_mfma_f32_16x16x32_bf16 v[44:47], v[60:63], v[100:103], v[44:47]
    ds_read_b64 v[132:133], v6 offset:2368
    v_mfma_f32_16x16x32_bf16 v[48:51], v[60:63], v[104:107], v[48:51]
    v_mfma_f32_16x16x32_bf16 v[32:35], v[64:67], v[84:87], v[32:35]
    ds_read_b64 v[134:135], v6 offset:2376
    v_mfma_f32_16x16x32_bf16 v[36:39], v[64:67], v[88:91], v[36:39]
    ds_read_b128 v[168:171], v12 offset:1344
    v_mfma_f32_16x16x32_bf16 v[40:43], v[64:67], v[92:95], v[40:43]
    v_mfma_f32_16x16x32_bf16 v[44:47], v[64:67], v[96:99], v[44:47]
    ds_read_b64 v[136:137], v6 offset:2880
    v_mfma_f32_16x16x32_bf16 v[48:51], v[64:67], v[100:103], v[48:51]
    ds_read_b64 v[138:139], v6 offset:2888
    v_mfma_f32_16x16x32_bf16 v[36:39], v[68:71], v[84:87], v[36:39]
    v_mfma_f32_16x16x32_bf16 v[40:43], v[68:71], v[88:91], v[40:43]
    ds_read_b128 v[172:175], v12 offset:832
    v_mfma_f32_16x16x32_bf16 v[44:47], v[68:71], v[92:95], v[44:47]
    ds_read_b64 v[140:141], v6 offset:3392
    v_mfma_f32_16x16x32_bf16 v[48:51], v[68:71], v[96:99], v[48:51]
    v_mfma_f32_16x16x32_bf16 v[40:43], v[72:75], v[84:87], v[40:43]
    ds_read_b64 v[142:143], v6 offset:3400
    v_mfma_f32_16x16x32_bf16 v[44:47], v[72:75], v[88:91], v[44:47]
    ds_read_b128 v[176:179], v12 offset:320
    v_mfma_f32_16x16x32_bf16 v[48:51], v[72:75], v[92:95], v[48:51]
    v_mfma_f32_16x16x32_bf16 v[44:47], v[76:79], v[84:87], v[44:47]
    ds_read_b64 v[144:145], v6 offset:3904
    v_mfma_f32_16x16x32_bf16 v[48:51], v[76:79], v[88:91], v[48:51]
    ds_read_b64 v[146:147], v6 offset:3912
    v_mfma_f32_16x16x32_bf16 v[48:51], v[80:83], v[84:87], v[48:51]
    s_waitcnt lgkmcnt(0)
    v_mfma_f32_16x16x32_bf16 v[20:23], v[116:119], v[148:151], v[20:23]
    ds_read_b128 v[84:87], v12 offset:3968
    v_mfma_f32_16x16x32_bf16 v[24:27], v[116:119], v[152:155], v[24:27]
    ds_read_b64 v[52:53], v6 offset:384
    v_mfma_f32_16x16x32_bf16 v[28:31], v[116:119], v[156:159], v[28:31]
    v_mfma_f32_16x16x32_bf16 v[32:35], v[116:119], v[160:163], v[32:35]
    ds_read_b64 v[54:55], v6 offset:392
    v_mfma_f32_16x16x32_bf16 v[36:39], v[116:119], v[164:167], v[36:39]
    ds_read_b128 v[88:91], v12 offset:3456
    v_mfma_f32_16x16x32_bf16 v[40:43], v[116:119], v[168:171], v[40:43]
    v_mfma_f32_16x16x32_bf16 v[44:47], v[116:119], v[172:175], v[44:47]
    ds_read_b64 v[56:57], v6 offset:896
    v_mfma_f32_16x16x32_bf16 v[48:51], v[116:119], v[176:179], v[48:51]
    ds_read_b64 v[58:59], v6 offset:904
    v_mfma_f32_16x16x32_bf16 v[24:27], v[120:123], v[148:151], v[24:27]
    v_mfma_f32_16x16x32_bf16 v[28:31], v[120:123], v[152:155], v[28:31]
    ds_read_b128 v[92:95], v12 offset:2944
    v_mfma_f32_16x16x32_bf16 v[32:35], v[120:123], v[156:159], v[32:35]
    ds_read_b64 v[60:61], v6 offset:1408
    v_mfma_f32_16x16x32_bf16 v[36:39], v[120:123], v[160:163], v[36:39]
    v_mfma_f32_16x16x32_bf16 v[40:43], v[120:123], v[164:167], v[40:43]
    ds_read_b64 v[62:63], v6 offset:1416
    v_mfma_f32_16x16x32_bf16 v[44:47], v[120:123], v[168:171], v[44:47]
    ds_read_b128 v[96:99], v12 offset:2432
    v_mfma_f32_16x16x32_bf16 v[48:51], v[120:123], v[172:175], v[48:51]
    v_mfma_f32_16x16x32_bf16 v[28:31], v[124:127], v[148:151], v[28:31]
    ds_read_b64 v[64:65], v6 offset:1920
    v_mfma_f32_16x16x32_bf16 v[32:35], v[124:127], v[152:155], v[32:35]
    ds_read_b64 v[66:67], v6 offset:1928
    v_mfma_f32_16x16x32_bf16 v[36:39], v[124:127], v[156:159], v[36:39]
    v_mfma_f32_16x16x32_bf16 v[40:43], v[124:127], v[160:163], v[40:43]
    ds_read_b128 v[100:103], v12 offset:1920
    v_mfma_f32_16x16x32_bf16 v[44:47], v[124:127], v[164:167], v[44:47]
    ds_read_b64 v[68:69], v6 offset:2432
    v_mfma_f32_16x16x32_bf16 v[48:51], v[124:127], v[168:171], v[48:51]
    v_mfma_f32_16x16x32_bf16 v[32:35], v[128:131], v[148:151], v[32:35]
    ds_read_b64 v[70:71], v6 offset:2440
    v_mfma_f32_16x16x32_bf16 v[36:39], v[128:131], v[152:155], v[36:39]
    ds_read_b128 v[104:107], v12 offset:1408
    v_mfma_f32_16x16x32_bf16 v[40:43], v[128:131], v[156:159], v[40:43]
    v_mfma_f32_16x16x32_bf16 v[44:47], v[128:131], v[160:163], v[44:47]
    ds_read_b64 v[72:73], v6 offset:2944
    v_mfma_f32_16x16x32_bf16 v[48:51], v[128:131], v[164:167], v[48:51]
    ds_read_b64 v[74:75], v6 offset:2952
    v_mfma_f32_16x16x32_bf16 v[36:39], v[132:135], v[148:151], v[36:39]
    v_mfma_f32_16x16x32_bf16 v[40:43], v[132:135], v[152:155], v[40:43]
    ds_read_b128 v[108:111], v12 offset:896
    v_mfma_f32_16x16x32_bf16 v[44:47], v[132:135], v[156:159], v[44:47]
    ds_read_b64 v[76:77], v6 offset:3456
    v_mfma_f32_16x16x32_bf16 v[48:51], v[132:135], v[160:163], v[48:51]
    v_mfma_f32_16x16x32_bf16 v[40:43], v[136:139], v[148:151], v[40:43]
    ds_read_b64 v[78:79], v6 offset:3464
    v_mfma_f32_16x16x32_bf16 v[44:47], v[136:139], v[152:155], v[44:47]
    ds_read_b128 v[112:115], v12 offset:384
    v_mfma_f32_16x16x32_bf16 v[48:51], v[136:139], v[156:159], v[48:51]
    v_mfma_f32_16x16x32_bf16 v[44:47], v[140:143], v[148:151], v[44:47]
    ds_read_b64 v[80:81], v6 offset:3968
    v_mfma_f32_16x16x32_bf16 v[48:51], v[140:143], v[152:155], v[48:51]
    ds_read_b64 v[82:83], v6 offset:3976
    v_mfma_f32_16x16x32_bf16 v[48:51], v[144:147], v[148:151], v[48:51]
    s_waitcnt lgkmcnt(0)
    v_mfma_f32_16x16x32_bf16 v[20:23], v[52:55], v[84:87], v[20:23]
    ds_read_b128 v[148:151], v12 offset:4032
    v_mfma_f32_16x16x32_bf16 v[24:27], v[52:55], v[88:91], v[24:27]
    ds_read_b64 v[116:117], v6 offset:448
    v_mfma_f32_16x16x32_bf16 v[28:31], v[52:55], v[92:95], v[28:31]
    v_mfma_f32_16x16x32_bf16 v[32:35], v[52:55], v[96:99], v[32:35]
    ds_read_b64 v[118:119], v6 offset:456
    v_mfma_f32_16x16x32_bf16 v[36:39], v[52:55], v[100:103], v[36:39]
    ds_read_b128 v[152:155], v12 offset:3520
    v_mfma_f32_16x16x32_bf16 v[40:43], v[52:55], v[104:107], v[40:43]
    v_mfma_f32_16x16x32_bf16 v[44:47], v[52:55], v[108:111], v[44:47]
    ds_read_b64 v[120:121], v6 offset:960
    v_mfma_f32_16x16x32_bf16 v[48:51], v[52:55], v[112:115], v[48:51]
    ds_read_b64 v[122:123], v6 offset:968
    v_mfma_f32_16x16x32_bf16 v[24:27], v[56:59], v[84:87], v[24:27]
    v_mfma_f32_16x16x32_bf16 v[28:31], v[56:59], v[88:91], v[28:31]
    ds_read_b128 v[156:159], v12 offset:3008
    v_mfma_f32_16x16x32_bf16 v[32:35], v[56:59], v[92:95], v[32:35]
    ds_read_b64 v[124:125], v6 offset:1472
    v_mfma_f32_16x16x32_bf16 v[36:39], v[56:59], v[96:99], v[36:39]
    v_mfma_f32_16x16x32_bf16 v[40:43], v[56:59], v[100:103], v[40:43]
    ds_read_b64 v[126:127], v6 offset:1480
    v_mfma_f32_16x16x32_bf16 v[44:47], v[56:59], v[104:107], v[44:47]
    ds_read_b128 v[160:163], v12 offset:2496
    v_mfma_f32_16x16x32_bf16 v[48:51], v[56:59], v[108:111], v[48:51]
    v_mfma_f32_16x16x32_bf16 v[28:31], v[60:63], v[84:87], v[28:31]
    ds_read_b64 v[128:129], v6 offset:1984
    v_mfma_f32_16x16x32_bf16 v[32:35], v[60:63], v[88:91], v[32:35]
    ds_read_b64 v[130:131], v6 offset:1992
    v_mfma_f32_16x16x32_bf16 v[36:39], v[60:63], v[92:95], v[36:39]
    v_mfma_f32_16x16x32_bf16 v[40:43], v[60:63], v[96:99], v[40:43]
    ds_read_b128 v[164:167], v12 offset:1984
    v_mfma_f32_16x16x32_bf16 v[44:47], v[60:63], v[100:103], v[44:47]
    ds_read_b64 v[132:133], v6 offset:2496
    v_mfma_f32_16x16x32_bf16 v[48:51], v[60:63], v[104:107], v[48:51]
    v_mfma_f32_16x16x32_bf16 v[32:35], v[64:67], v[84:87], v[32:35]
    ds_read_b64 v[134:135], v6 offset:2504
    v_mfma_f32_16x16x32_bf16 v[36:39], v[64:67], v[88:91], v[36:39]
    ds_read_b128 v[168:171], v12 offset:1472
    v_mfma_f32_16x16x32_bf16 v[40:43], v[64:67], v[92:95], v[40:43]
    v_mfma_f32_16x16x32_bf16 v[44:47], v[64:67], v[96:99], v[44:47]
    ds_read_b64 v[136:137], v6 offset:3008
    v_mfma_f32_16x16x32_bf16 v[48:51], v[64:67], v[100:103], v[48:51]
    ds_read_b64 v[138:139], v6 offset:3016
    v_mfma_f32_16x16x32_bf16 v[36:39], v[68:71], v[84:87], v[36:39]
    v_mfma_f32_16x16x32_bf16 v[40:43], v[68:71], v[88:91], v[40:43]
    ds_read_b128 v[172:175], v12 offset:960
    v_mfma_f32_16x16x32_bf16 v[44:47], v[68:71], v[92:95], v[44:47]
    ds_read_b64 v[140:141], v6 offset:3520
    v_mfma_f32_16x16x32_bf16 v[48:51], v[68:71], v[96:99], v[48:51]
    v_mfma_f32_16x16x32_bf16 v[40:43], v[72:75], v[84:87], v[40:43]
    ds_read_b64 v[142:143], v6 offset:3528
    v_mfma_f32_16x16x32_bf16 v[44:47], v[72:75], v[88:91], v[44:47]
    ds_read_b128 v[176:179], v12 offset:448
    v_mfma_f32_16x16x32_bf16 v[48:51], v[72:75], v[92:95], v[48:51]
    v_mfma_f32_16x16x32_bf16 v[44:47], v[76:79], v[84:87], v[44:47]
    ds_read_b64 v[144:145], v6 offset:4032
    v_mfma_f32_16x16x32_bf16 v[48:51], v[76:79], v[88:91], v[48:51]
    ds_read_b64 v[146:147], v6 offset:4040
    v_mfma_f32_16x16x32_bf16 v[48:51], v[80:83], v[84:87], v[48:51]
    s_waitcnt lgkmcnt(0)
    v_mfma_f32_16x16x32_bf16 v[20:23], v[116:119], v[148:151], v[20:23]
    v_mfma_f32_16x16x32_bf16 v[24:27], v[116:119], v[152:155], v[24:27]
    v_mfma_f32_16x16x32_bf16 v[28:31], v[116:119], v[156:159], v[28:31]
    v_mfma_f32_16x16x32_bf16 v[32:35], v[116:119], v[160:163], v[32:35]
    v_mfma_f32_16x16x32_bf16 v[36:39], v[116:119], v[164:167], v[36:39]
    v_mfma_f32_16x16x32_bf16 v[40:43], v[116:119], v[168:171], v[40:43]
    v_mfma_f32_16x16x32_bf16 v[44:47], v[116:119], v[172:175], v[44:47]
    v_mfma_f32_16x16x32_bf16 v[48:51], v[116:119], v[176:179], v[48:51]
    v_mfma_f32_16x16x32_bf16 v[24:27], v[120:123], v[148:151], v[24:27]
    v_mfma_f32_16x16x32_bf16 v[28:31], v[120:123], v[152:155], v[28:31]
    v_mfma_f32_16x16x32_bf16 v[32:35], v[120:123], v[156:159], v[32:35]
    v_mfma_f32_16x16x32_bf16 v[36:39], v[120:123], v[160:163], v[36:39]
    v_mfma_f32_16x16x32_bf16 v[40:43], v[120:123], v[164:167], v[40:43]
    v_mfma_f32_16x16x32_bf16 v[44:47], v[120:123], v[168:171], v[44:47]
    v_mfma_f32_16x16x32_bf16 v[48:51], v[120:123], v[172:175], v[48:51]
    v_mfma_f32_16x16x32_bf16 v[28:31], v[124:127], v[148:151], v[28:31]
    v_mfma_f32_16x16x32_bf16 v[32:35], v[124:127], v[152:155], v[32:35]
    v_mfma_f32_16x16x32_bf16 v[36:39], v[124:127], v[156:159], v[36:39]
    v_mfma_f32_16x16x32_bf16 v[40:43], v[124:127], v[160:163], v[40:43]
    v_mfma_f32_16x16x32_bf16 v[44:47], v[124:127], v[164:167], v[44:47]
    v_mfma_f32_16x16x32_bf16 v[48:51], v[124:127], v[168:171], v[48:51]
    v_mfma_f32_16x16x32_bf16 v[32:35], v[128:131], v[148:151], v[32:35]
    v_mfma_f32_16x16x32_bf16 v[36:39], v[128:131], v[152:155], v[36:39]
    v_mfma_f32_16x16x32_bf16 v[40:43], v[128:131], v[156:159], v[40:43]
    v_mfma_f32_16x16x32_bf16 v[44:47], v[128:131], v[160:163], v[44:47]
    v_mfma_f32_16x16x32_bf16 v[48:51], v[128:131], v[164:167], v[48:51]
    v_mfma_f32_16x16x32_bf16 v[36:39], v[132:135], v[148:151], v[36:39]
    v_mfma_f32_16x16x32_bf16 v[40:43], v[132:135], v[152:155], v[40:43]
    v_mfma_f32_16x16x32_bf16 v[44:47], v[132:135], v[156:159], v[44:47]
    v_mfma_f32_16x16x32_bf16 v[48:51], v[132:135], v[160:163], v[48:51]
    v_mfma_f32_16x16x32_bf16 v[40:43], v[136:139], v[148:151], v[40:43]
    v_mfma_f32_16x16x32_bf16 v[44:47], v[136:139], v[152:155], v[44:47]
    v_mfma_f32_16x16x32_bf16 v[48:51], v[136:139], v[156:159], v[48:51]
    v_mfma_f32_16x16x32_bf16 v[44:47], v[140:143], v[148:151], v[44:47]
    v_mfma_f32_16x16x32_bf16 v[48:51], v[140:143], v[152:155], v[48:51]
    v_mfma_f32_16x16x32_bf16 v[48:51], v[144:147], v[148:151], v[48:51]
    s_setprio 3
    ds_read_b64 v[52:53], v14 offset:3584
    ds_read_b64 v[54:55], v14 offset:3072
    ds_read_b64 v[56:57], v14 offset:2560
    ds_read_b64 v[58:59], v14 offset:2048
    ds_read_b64 v[60:61], v14 offset:1536
    ds_read_b64 v[62:63], v14 offset:1024
    ds_read_b64 v[64:65], v14 offset:512
    ds_read_b64 v[66:67], v14 offset:0
    s_and_b32 s53, s100, 1
    s_lshl_b32 s53, s53, 4
    s_lshr_b32 s52, s52, s53
    s_lshl_b32 s52, s52, 16
    s_mov_b32 s53, s52
    s_add_u32 s49, s101, 10485760
    s_waitcnt lgkmcnt(0)
    v_and_b32 v70, 0xffff0000, v53
    v_lshlrev_b32 v71, 16, v53
    v_and_b32 v72, 0xffff0000, v52
    v_lshlrev_b32 v73, 16, v52
    v_pk_mul_f32 v[70:71], v[70:71], s[52:53]
    v_pk_mul_f32 v[72:73], v[72:73], s[52:53]
    v_cvt_pk_bf16_f32 v74, v70, v71
    v_lshlrev_b32 v70, 16, v74
    v_and_b32 v71, 0xffff0000, v74
    v_cvt_pk_bf16_f32 v75, v72, v73
    v_lshlrev_b32 v72, 16, v75
    v_and_b32 v73, 0xffff0000, v75
    v_cvt_pk_bf16_f32 v74, v20, v21
    v_lshlrev_b32 v20, 16, v74
    v_and_b32 v21, 0xffff0000, v74
    v_cvt_pk_bf16_f32 v75, v22, v23
    v_lshlrev_b32 v22, 16, v75
    v_and_b32 v23, 0xffff0000, v75
    v_pk_add_f32 v[20:21], v[20:21], v[70:71]
    v_pk_add_f32 v[22:23], v[22:23], v[72:73]
    v_cvt_pk_bf16_f32 v80, v20, v21
    v_cvt_pk_bf16_f32 v81, v22, v23
    ds_write_b64 v13, v[80:81] offset:0
    v_and_b32 v70, 0xffff0000, v55
    v_lshlrev_b32 v71, 16, v55
    v_and_b32 v72, 0xffff0000, v54
    v_lshlrev_b32 v73, 16, v54
    v_pk_mul_f32 v[70:71], v[70:71], s[52:53]
    v_pk_mul_f32 v[72:73], v[72:73], s[52:53]
    v_cvt_pk_bf16_f32 v74, v70, v71
    v_lshlrev_b32 v70, 16, v74
    v_and_b32 v71, 0xffff0000, v74
    v_cvt_pk_bf16_f32 v75, v72, v73
    v_lshlrev_b32 v72, 16, v75
    v_and_b32 v73, 0xffff0000, v75
    v_cvt_pk_bf16_f32 v74, v24, v25
    v_lshlrev_b32 v24, 16, v74
    v_and_b32 v25, 0xffff0000, v74
    v_cvt_pk_bf16_f32 v75, v26, v27
    v_lshlrev_b32 v26, 16, v75
    v_and_b32 v27, 0xffff0000, v75
    v_pk_add_f32 v[24:25], v[24:25], v[70:71]
    v_pk_add_f32 v[26:27], v[26:27], v[72:73]
    v_cvt_pk_bf16_f32 v82, v24, v25
    v_cvt_pk_bf16_f32 v83, v26, v27
    ds_write_b64 v13, v[82:83] offset:512
    s_waitcnt lgkmcnt(0)
    ds_read_b128 v[88:91], v4 offset:0
    v_and_b32 v70, 0xffff0000, v57
    v_lshlrev_b32 v71, 16, v57
    v_and_b32 v72, 0xffff0000, v56
    v_lshlrev_b32 v73, 16, v56
    v_pk_mul_f32 v[70:71], v[70:71], s[52:53]
    v_pk_mul_f32 v[72:73], v[72:73], s[52:53]
    v_cvt_pk_bf16_f32 v74, v70, v71
    v_lshlrev_b32 v70, 16, v74
    v_and_b32 v71, 0xffff0000, v74
    v_cvt_pk_bf16_f32 v75, v72, v73
    v_lshlrev_b32 v72, 16, v75
    v_and_b32 v73, 0xffff0000, v75
    v_cvt_pk_bf16_f32 v74, v28, v29
    v_lshlrev_b32 v28, 16, v74
    v_and_b32 v29, 0xffff0000, v74
    v_cvt_pk_bf16_f32 v75, v30, v31
    v_lshlrev_b32 v30, 16, v75
    v_and_b32 v31, 0xffff0000, v75
    v_pk_add_f32 v[28:29], v[28:29], v[70:71]
    v_pk_add_f32 v[30:31], v[30:31], v[72:73]
    v_cvt_pk_bf16_f32 v84, v28, v29
    v_cvt_pk_bf16_f32 v85, v30, v31
    ds_write_b64 v13, v[84:85] offset:1024
    v_and_b32 v70, 0xffff0000, v59
    v_lshlrev_b32 v71, 16, v59
    v_and_b32 v72, 0xffff0000, v58
    v_lshlrev_b32 v73, 16, v58
    v_pk_mul_f32 v[70:71], v[70:71], s[52:53]
    v_pk_mul_f32 v[72:73], v[72:73], s[52:53]
    v_cvt_pk_bf16_f32 v74, v70, v71
    v_lshlrev_b32 v70, 16, v74
    v_and_b32 v71, 0xffff0000, v74
    v_cvt_pk_bf16_f32 v75, v72, v73
    v_lshlrev_b32 v72, 16, v75
    v_and_b32 v73, 0xffff0000, v75
    v_cvt_pk_bf16_f32 v74, v32, v33
    v_lshlrev_b32 v32, 16, v74
    v_and_b32 v33, 0xffff0000, v74
    v_cvt_pk_bf16_f32 v75, v34, v35
    v_lshlrev_b32 v34, 16, v75
    v_and_b32 v35, 0xffff0000, v75
    v_pk_add_f32 v[32:33], v[32:33], v[70:71]
    v_pk_add_f32 v[34:35], v[34:35], v[72:73]
    v_cvt_pk_bf16_f32 v86, v32, v33
    v_cvt_pk_bf16_f32 v87, v34, v35
    ds_write_b64 v13, v[86:87] offset:1536
    s_waitcnt lgkmcnt(0)
    ds_read_b128 v[92:95], v4 offset:1024
    buffer_store_dwordx4 v[88:91], v3, s[28:31], s49 offen offset:0 sc1
    v_and_b32 v70, 0xffff0000, v61
    v_lshlrev_b32 v71, 16, v61
    v_and_b32 v72, 0xffff0000, v60
    v_lshlrev_b32 v73, 16, v60
    v_pk_mul_f32 v[70:71], v[70:71], s[52:53]
    v_pk_mul_f32 v[72:73], v[72:73], s[52:53]
    v_cvt_pk_bf16_f32 v74, v70, v71
    v_lshlrev_b32 v70, 16, v74
    v_and_b32 v71, 0xffff0000, v74
    v_cvt_pk_bf16_f32 v75, v72, v73
    v_lshlrev_b32 v72, 16, v75
    v_and_b32 v73, 0xffff0000, v75
    v_cvt_pk_bf16_f32 v74, v36, v37
    v_lshlrev_b32 v36, 16, v74
    v_and_b32 v37, 0xffff0000, v74
    v_cvt_pk_bf16_f32 v75, v38, v39
    v_lshlrev_b32 v38, 16, v75
    v_and_b32 v39, 0xffff0000, v75
    v_pk_add_f32 v[36:37], v[36:37], v[70:71]
    v_pk_add_f32 v[38:39], v[38:39], v[72:73]
    v_cvt_pk_bf16_f32 v80, v36, v37
    v_cvt_pk_bf16_f32 v81, v38, v39
    ds_write_b64 v13, v[80:81] offset:2048
    v_and_b32 v70, 0xffff0000, v63
    v_lshlrev_b32 v71, 16, v63
    v_and_b32 v72, 0xffff0000, v62
    v_lshlrev_b32 v73, 16, v62
    v_pk_mul_f32 v[70:71], v[70:71], s[52:53]
    v_pk_mul_f32 v[72:73], v[72:73], s[52:53]
    v_cvt_pk_bf16_f32 v74, v70, v71
    v_lshlrev_b32 v70, 16, v74
    v_and_b32 v71, 0xffff0000, v74
    v_cvt_pk_bf16_f32 v75, v72, v73
    v_lshlrev_b32 v72, 16, v75
    v_and_b32 v73, 0xffff0000, v75
    v_cvt_pk_bf16_f32 v74, v40, v41
    v_lshlrev_b32 v40, 16, v74
    v_and_b32 v41, 0xffff0000, v74
    v_cvt_pk_bf16_f32 v75, v42, v43
    v_lshlrev_b32 v42, 16, v75
    v_and_b32 v43, 0xffff0000, v75
    v_pk_add_f32 v[40:41], v[40:41], v[70:71]
    v_pk_add_f32 v[42:43], v[42:43], v[72:73]
    v_cvt_pk_bf16_f32 v82, v40, v41
    v_cvt_pk_bf16_f32 v83, v42, v43
    ds_write_b64 v13, v[82:83] offset:2560
    s_waitcnt lgkmcnt(0)
    ds_read_b128 v[96:99], v4 offset:2048
    buffer_store_dwordx4 v[92:95], v3, s[28:31], s49 offen offset:1024 sc1
    v_and_b32 v70, 0xffff0000, v65
    v_lshlrev_b32 v71, 16, v65
    v_and_b32 v72, 0xffff0000, v64
    v_lshlrev_b32 v73, 16, v64
    v_pk_mul_f32 v[70:71], v[70:71], s[52:53]
    v_pk_mul_f32 v[72:73], v[72:73], s[52:53]
    v_cvt_pk_bf16_f32 v74, v70, v71
    v_lshlrev_b32 v70, 16, v74
    v_and_b32 v71, 0xffff0000, v74
    v_cvt_pk_bf16_f32 v75, v72, v73
    v_lshlrev_b32 v72, 16, v75
    v_and_b32 v73, 0xffff0000, v75
    v_cvt_pk_bf16_f32 v74, v44, v45
    v_lshlrev_b32 v44, 16, v74
    v_and_b32 v45, 0xffff0000, v74
    v_cvt_pk_bf16_f32 v75, v46, v47
    v_lshlrev_b32 v46, 16, v75
    v_and_b32 v47, 0xffff0000, v75
    v_pk_add_f32 v[44:45], v[44:45], v[70:71]
    v_pk_add_f32 v[46:47], v[46:47], v[72:73]
    v_cvt_pk_bf16_f32 v84, v44, v45
    v_cvt_pk_bf16_f32 v85, v46, v47
    ds_write_b64 v13, v[84:85] offset:3072
    v_and_b32 v70, 0xffff0000, v67
    v_lshlrev_b32 v71, 16, v67
    v_and_b32 v72, 0xffff0000, v66
    v_lshlrev_b32 v73, 16, v66
    v_pk_mul_f32 v[70:71], v[70:71], s[52:53]
    v_pk_mul_f32 v[72:73], v[72:73], s[52:53]
    v_cvt_pk_bf16_f32 v74, v70, v71
    v_lshlrev_b32 v70, 16, v74
    v_and_b32 v71, 0xffff0000, v74
    v_cvt_pk_bf16_f32 v75, v72, v73
    v_lshlrev_b32 v72, 16, v75
    v_and_b32 v73, 0xffff0000, v75
    v_cvt_pk_bf16_f32 v74, v48, v49
    v_lshlrev_b32 v48, 16, v74
    v_and_b32 v49, 0xffff0000, v74
    v_cvt_pk_bf16_f32 v75, v50, v51
    v_lshlrev_b32 v50, 16, v75
    v_and_b32 v51, 0xffff0000, v75
    v_pk_add_f32 v[48:49], v[48:49], v[70:71]
    v_pk_add_f32 v[50:51], v[50:51], v[72:73]
    v_cvt_pk_bf16_f32 v86, v48, v49
    v_cvt_pk_bf16_f32 v87, v50, v51
    ds_write_b64 v13, v[86:87] offset:3584
    s_waitcnt lgkmcnt(0)
    ds_read_b128 v[100:103], v4 offset:3072
    buffer_store_dwordx4 v[96:99], v3, s[28:31], s49 offen offset:2048 sc1
    s_waitcnt lgkmcnt(0)
    buffer_store_dwordx4 v[100:103], v3, s[28:31], s49 offen offset:3072 sc1
    s_mul_i32 s48, s100, 205
    s_lshr_b32 s48, s48, 14
    s_lshl_b32 s49, s48, 8
    s_add_u32 s49, s49, 16980224
    v_mov_b32 v5, s49
    v_mov_b32 v6, 1
    s_waitcnt vmcnt(0)
    s_mov_b64 exec, 1
    buffer_atomic_add v6, v5, s[28:31], 0 offen sc0 sc1
    s_mov_b64 exec, -1
    v_lshrrev_b32 v7, 3, v2
    v_lshlrev_b32 v7, 3, v7
    v_add_u32 v7, s48, v7
    v_lshlrev_b32 v7, 3, v7
    v_and_b32 v8, 7, v2
    v_add_u32 v7, v7, v8
    v_lshlrev_b32 v7, 7, v7
    v_add_u32 v7, 16990304, v7
    v_mov_b32 v8, 1
    s_waitcnt vmcnt(0)
    v_readfirstlane_b32 s49, v6
    s_cmp_lg_u32 s49, 79
    s_cbranch_scc1 F_CVNL
    s_mov_b32 exec_lo, -1
    s_mov_b32 exec_hi, 0
    buffer_store_dword v8, v7, s[28:31], 0 offen sc1
    s_mov_b64 exec, -1
F_CVNL:
    s_endpgm
F_HELP:
    v_mov_b32 v13, 160256
    v_mov_b32 v8, 1
    v_and_b32 v5, 31, v2
    v_lshlrev_b32 v5, 2, v5
    s_lshl_b32 s59, s2, 7
    s_add_u32 s59, s59, 16990208
    s_mov_b32 s94, 0
F_HLOOP:
    buffer_load_dword v20, v5, s[28:31], s59 offen sc1
    s_waitcnt vmcnt(0)
    v_cmp_eq_u32 vcc, 1, v20
    s_and_b32 s49, vcc_lo, 0xff
    s_cmp_eq_u32 s49, 0xff
    s_cselect_b32 s49, 1, 0
    s_and_b32 s50, vcc_lo, 0x3fff00
    s_cmp_eq_u32 s50, 0x3fff00
    s_cselect_b32 s50, 1, 0
    v_mov_b32 v22, s49
    v_mov_b32 v23, s50
    ds_max_u32 v13, v22 offset:8
    ds_max_u32 v13, v23 offset:12
    s_lshr_b32 s51, vcc_lo, 24
    s_and_b32 s51, s51, s50
    s_and_b32 s51, s51, 1
    s_cmp_eq_u32 s51, 1
    s_cbranch_scc1 F_HY
    s_sleep 4
    s_add_u32 s94, s94, 1
    s_cmp_lt_u32 s94, 0x100000
    s_cbranch_scc1 F_HLOOP
F_HY:
    s_mul_i32 s48, s36, 327680
    s_nop 0
    s_lshl_b32 s49, s34, 7
    s_add_u32 s48, s48, s49
    s_add_u32 s48, s48, 10485760
    v_lshrrev_b32 v5, 3, v2
    v_lshlrev_b32 v5, 12, v5
    v_and_b32 v6, 7, v2
    v_lshl_add_u32 v5, v6, 4, v5
    v_lshlrev_b32 v6, 4, v2
    v_add_u32 v6, 76032, v6
    buffer_load_dwordx4 v[24:27], v5, s[28:31], s48 offen sc1
    s_add_u32 s48, s48, 32768
    buffer_load_dwordx4 v[28:31], v5, s[28:31], s48 offen sc1
    s_add_u32 s48, s48, 32768
    buffer_load_dwordx4 v[32:35], v5, s[28:31], s48 offen sc1
    s_add_u32 s48, s48, 32768
    buffer_load_dwordx4 v[36:39], v5, s[28:31], s48 offen sc1
    s_add_u32 s48, s48, 32768
    buffer_load_dwordx4 v[40:43], v5, s[28:31], s48 offen sc1
    s_add_u32 s48, s48, 32768
    buffer_load_dwordx4 v[44:47], v5, s[28:31], s48 offen sc1
    s_add_u32 s48, s48, 32768
    buffer_load_dwordx4 v[48:51], v5, s[28:31], s48 offen sc1
    s_add_u32 s48, s48, 32768
    buffer_load_dwordx4 v[52:55], v5, s[28:31], s48 offen sc1
    s_add_u32 s48, s48, 32768
    buffer_load_dwordx4 v[56:59], v5, s[28:31], s48 offen sc1
    s_add_u32 s48, s48, 32768
    buffer_load_dwordx4 v[60:63], v5, s[28:31], s48 offen sc1
    s_add_u32 s48, s48, 32768
    s_waitcnt vmcnt(9)
    ds_write_b128 v6, v[24:27] offset:0
    s_waitcnt vmcnt(8)
    ds_write_b128 v6, v[28:31] offset:1024
    s_waitcnt vmcnt(7)
    ds_write_b128 v6, v[32:35] offset:2048
    s_waitcnt vmcnt(6)
    ds_write_b128 v6, v[36:39] offset:3072
    s_waitcnt vmcnt(5)
    ds_write_b128 v6, v[40:43] offset:4096
    s_waitcnt vmcnt(4)
    ds_write_b128 v6, v[44:47] offset:5120
    s_waitcnt vmcnt(3)
    ds_write_b128 v6, v[48:51] offset:6144
    s_waitcnt vmcnt(2)
    ds_write_b128 v6, v[52:55] offset:7168
    s_waitcnt vmcnt(1)
    ds_write_b128 v6, v[56:59] offset:8192
    s_waitcnt vmcnt(0)
    ds_write_b128 v6, v[60:63] offset:9216
    s_waitcnt lgkmcnt(0)
    ds_write_b32 v13, v8 offset:16
K1_END:
    s_endpgm

.section .rodata,"a"
.p2align 6
.amdhsa_kernel recurrent_scan__ssm_conv_h3__dense_activation_silu__prompt_kernel
  .amdhsa_next_free_vgpr 250
  .amdhsa_next_free_sgpr 102
  .amdhsa_accum_offset 252
  .amdhsa_group_segment_fixed_size 0
  .amdhsa_kernarg_size 96
  .amdhsa_user_sgpr_count 2
  .amdhsa_user_sgpr_kernarg_segment_ptr 1
  .amdhsa_system_sgpr_workgroup_id_x 1
  .amdhsa_float_denorm_mode_32 3
  .amdhsa_float_denorm_mode_16_64 3
.end_amdhsa_kernel
```
